```python
import torch

def _softmax(x, axis=-1):
    return torch.softmax(x, dim=axis)
def _gelu(x):
    return torch.nn.functional.gelu(x, approximate="tanh")
def _silu(x):
    return torch.nn.functional.silu(x)
def _sigmoid(x):
    return torch.sigmoid(x)
def _layernorm(x, axis=-1, eps=1e-5):
    m = x.mean(dim=axis, keepdim=True)
    v = x.var(dim=axis, keepdim=True, unbiased=False)
    return (x - m) / torch.sqrt(v + eps)
def _scatter_add(tgt, idx, src, axis=0):
    return tgt.clone().index_add_(axis, idx, src)
def _segment_sum(src, seg, n):
    out = torch.zeros((n,) + src.shape[1:], dtype=src.dtype)
    return out.index_add_(0, seg, src)
def _pad(x, pw):
    flat = tuple(v for pair in reversed(pw) for v in pair)
    return torch.nn.functional.pad(x, flat)

kernel_name = 'gated_mix__linear_kernel_hedgehog__grouped_kv_mqa__prompt'

def setup_inputs():

    _w = (lambda a: (lambda t: t.to(torch.bfloat16) if t.is_floating_point() else t)(torch.as_tensor(a)))
    def _A_setup():
        B, S, D, H = 1, 2048, 448, 16
        Dh = D // H
        return {
            "x": _w((lambda *s: torch.randn(*s, dtype=torch.bfloat16) * 0.05)(B, S, D)),
            "wqkv": _w((lambda *s: torch.randn(*s, dtype=torch.bfloat16) * 1.6)(D, 3 * D)),
            "w_phi": _w((lambda *s: torch.randn(*s, dtype=torch.bfloat16) * 1.6)(H, Dh, Dh) * (Dh ** -0.5)),
            "wo": _w((lambda *s: torch.randn(*s, dtype=torch.bfloat16) * 0.05)(D, D)),
        }
    _A_in = _A_setup()

    def _B_setup():
        B, S, D, H = 1, 2048, 448, 16
        Dh = D // H
        return {
            "x": _w((lambda *s: torch.randn(*s, dtype=torch.bfloat16) * 0.05)(B, S, D)),
            "wq": _w((lambda *s: torch.randn(*s, dtype=torch.bfloat16) * 1.6)(D, H * Dh)),
            "wk": _w((lambda *s: torch.randn(*s, dtype=torch.bfloat16) * 1.6)(D, Dh)),
            "wv": _w((lambda *s: torch.randn(*s, dtype=torch.bfloat16) * 0.05)(D, Dh)),
            "wo": _w((lambda *s: torch.randn(*s, dtype=torch.bfloat16) * 0.05)(H * Dh, D)),
        }
    _B_in = _B_setup()

    return {
        "A_x": _A_in["x"],
        "A_wqkv": _A_in["wqkv"],
        "A_w_phi": _A_in["w_phi"],
        "A_wo": _A_in["wo"],
        "B_x": _B_in["x"],
        "B_wq": _B_in["wq"],
        "B_wk": _B_in["wk"],
        "B_wv": _B_in["wv"],
        "B_wo": _B_in["wo"],
        "gate_w": _w((lambda *s: torch.randn(*s, dtype=torch.bfloat16) * 0.05)(448) * 16.0),
    }

def reference(A_x, A_wqkv, A_w_phi, A_wo, B_x, B_wq, B_wk, B_wv, B_wo, gate_w):
    def _A_ref(x, wqkv, w_phi, wo):
        B, S, D = x.shape
        H = 16; Dh = D // H
        qkv = (lambda x, *d: x.permute(*d))((x @ wqkv).reshape(B, S, 3, H, Dh), 2, 0, 3, 1, 4)
        q, k, v = qkv[0], qkv[1], qkv[2]
        pq = torch.einsum("bhsd,hdf->bhsf", q, w_phi)
        pk = torch.einsum("bhsd,hdf->bhsf", k, w_phi)
        phi_q = torch.concatenate([_softmax(pq, axis=-1), _softmax(-pq, axis=-1)], axis=-1)
        phi_k = torch.concatenate([_softmax(pk, axis=-1), _softmax(-pk, axis=-1)], axis=-1)
        kv = torch.einsum("bhsf,bhsd->bhfd", phi_k, v)
        z  = torch.einsum("bhsf->bhf", phi_k)
        num = torch.einsum("bhqf,bhfd->bhqd", phi_q, kv)
        den = torch.einsum("bhqf,bhf->bhq", phi_q, z)[..., None] + 1e-6
        o = num / den
        return (lambda x, *d: x.permute(*d))(o, 0, 2, 1, 3).reshape(B, S, D) @ wo

    def _B_ref(x, wq, wk, wv, wo):
        B, S, D = x.shape
        H = 16
        Dh = D // H
        q = (lambda x, *d: x.permute(*d))((x @ wq).reshape(B, S, H, Dh), 0, 2, 1, 3)
        k = x @ wk
        v = x @ wv
        scores = torch.einsum("bhqd,bkd->bhqk", q, k) * (Dh ** -0.5)
        p = _softmax(scores, axis=-1)
        o = torch.einsum("bhqk,bkd->bhqd", p, v)
        return (lambda x, *d: x.permute(*d))(o, 0, 2, 1, 3).reshape(B, S, H * Dh) @ wo

    x = A_x
    g = _sigmoid((x * gate_w).sum(-1, keepdims=True))
    a = _A_ref(x, A_wqkv, A_w_phi, A_wo)
    b = _B_ref(x, B_wq, B_wk, B_wv, B_wo)
    return g * a + (1 - g) * b
```

```asm
; @launch grid=(256,1,1) block=(512,1,1) lds=163840
.amdgcn_target "amdgcn-amd-amdhsa--gfx950"
.text
.globl gated_mix__linear_kernel_hedgehog__grouped_kv_mqa__prompt_kernel
.p2align 8
.type gated_mix__linear_kernel_hedgehog__grouped_kv_mqa__prompt_kernel,@function
gated_mix__linear_kernel_hedgehog__grouped_kv_mqa__prompt_kernel:
    s_cmp_ge_u32 s2, 256
    s_cbranch_scc1 L_end
    s_load_dwordx16 s[32:47], s[0:1], 0
    s_load_dwordx8 s[48:55], s[0:1], 64
    s_load_dwordx2 s[56:57], s[0:1], 96
    s_getpc_b64 s[92:93]
    v_lshrrev_b32 v1, 6, v0
    v_and_b32 v2, 7, v0
    s_bfe_u32 s3, s2, 0x30003
    v_readfirstlane_b32 s24, v1
    v_lshl_add_u32 v2, v1, 3, v2
    v_lshl_add_u32 v2, s3, 6, v2
    v_lshlrev_b32 v2, 7, v2
    v_min_u32 v2, CODE_LAST, v2
    s_mov_b64 exec, 0xff
    global_load_dword v1, v2, s[92:93]
    s_mov_b64 exec, -1
    v_and_b32 v0, 63, v0
    s_and_b32 s3, s2, 7
    s_lshr_b32 s27, s2, 3
    s_lshr_b32 s61, s3, 1
    s_and_b32 s62, s3, 1
    s_lshl_b32 s30, s61, 2
    s_lshr_b32 s63, s27, 3
    s_add_u32 s30, s30, s63
    s_lshl_b32 s31, s62, 3
    s_and_b32 s63, s27, 7
    s_add_u32 s31, s31, s63
    s_and_b32 s25, s24, 3
    s_lshr_b32 s28, s25, 1
    s_and_b32 s29, s25, 1
    s_lshl_b32 s59, s30, 2
    s_add_u32 s59, s59, s25
    s_lshl_b32 s79, s30, 4
    s_add_u32 s79, s79, s31
    s_mov_b32 s26, 0
    s_cmp_eq_u32 s31, 0
    s_cselect_b32 s26, 2, s26
    s_cmp_eq_u32 s31, 15
    s_cselect_b32 s26, 1, s26
    s_cmp_gt_u32 s31, 15
    s_cselect_b32 s92, 2, 1
    s_sub_u32 s92, s31, s92
    s_cmp_ge_u32 s92, 7
    s_cselect_b32 s93, 1, 0
    s_cselect_b32 s60, 7, 0
    s_sub_u32 s92, s92, s60
    v_lshlrev_b32 v2, 4, v0
    v_lshrrev_b32 v4, 5, v0
    v_mov_b32 v5, 163584
    v_mov_b32 v6, 1
    s_mov_b32 s80, 0x3fb8aa3b
    s_mov_b32 s81, 0x3fb8aa3b
    s_lshl_b32 s77, s25, 10
    s_lshr_b32 s75, s27, 3
    s_and_b32 s60, s27, 7
    s_add_u32 s60, s60, s75
    s_lshl_b32 s60, s60, 2
    s_mov_b32 s62, 0x20420420
    s_mov_b32 s63, 0x204
    s_lshr_b64 s[62:63], s[62:63], s60
    s_and_b32 s75, s62, 15
    s_lshl_b32 s60, s31, 2
    s_mov_b32 s62, 0x75634120
    s_mov_b32 s63, 0xfdebc9a8
    s_lshr_b64 s[62:63], s[62:63], s60
    s_and_b32 s94, s62, 15
    s_mov_b32 s62, 0x67452310
    s_mov_b32 s63, 0xfecdab89
    s_lshr_b64 s[62:63], s[62:63], s60
    s_and_b32 s95, s62, 15
    s_mul_i32 s73, s95, 56
    s_mul_i32 s60, s25, 14336
    s_add_u32 s73, s73, s60
    s_mul_i32 s60, s25, 43008
    s_mul_i32 s72, s31, 56
    s_add_u32 s72, s72, s60
    s_mul_i32 s96, s94, 56
    s_add_u32 s96, s96, s60
    s_lshl_b32 s76, s25, 14
    v_lshrrev_b32 v8, 2, v0
    v_and_b32 v9, 3, v0
    v_lshlrev_b32 v9, 4, v9
    v_min_u32 v9, 40, v9
    v_mul_u32_u24 v10, 2688, v8
    v_add_u32 v10, v10, v9
    s_cmp_ge_u32 s24, 4
    s_cbranch_scc1 L_g1
    v_mul_u32_u24 v11, 56, v8
    v_add_u32 v11, v11, v9
    v_mul_u32_u24 v16, 896, v8
    v_add_u32 v16, v16, v9
    s_mul_i32 s74, s25, 896
    v_mov_b32 v12, 0
    v_lshlrev_b32 v13, 2, v0
    v_add_u32 v13, 163584, v13
    ds_write_b32 v13, v12
    v_lshrrev_b32 v12, 4, v0
    v_add_u32 v12, s75, v12
    v_add_u32 v13, 4, v12
    v_subrev_u32 v14, 7, v12
    v_min_u32 v12, v12, v14
    v_subrev_u32 v14, 7, v13
    v_min_u32 v13, v13, v14
    v_and_b32 v14, 15, v0
    v_lshlrev_b32 v14, 1, v14
    v_lshl_add_u32 v12, v12, 7, v14
    v_lshl_add_u32 v13, v13, 7, v14
    s_lshl_b32 s66, s25, 5
    s_mul_i32 s68, s59, 28672
    v_lshrrev_b32 v22, 3, v0
    v_mul_u32_u24 v22, 896, v22
    v_and_b32 v23, 7, v0
    v_lshrrev_b32 v14, 4, v0
    v_xor_b32 v23, v23, v14
    v_lshl_add_u32 v22, v23, 4, v22
    v_xor_b32 v23, 64, v22
    s_waitcnt lgkmcnt(0)
    s_mov_b32 s4, s32
    s_mov_b32 s5, s33
    s_mov_b32 s6, 1835008
    s_mov_b32 s7, 0x00020000
    s_mov_b32 s12, s34
    s_mov_b32 s13, s35
    s_mov_b32 s14, 1204224
    s_mov_b32 s15, 0x00020000
    s_mov_b32 s8, s42
    s_mov_b32 s9, s43
    s_mov_b32 s10, 401408
    s_mov_b32 s11, 0x00020000
    s_mov_b32 s67, s75
    s_cmp_lg_u32 s26, 0
    s_cbranch_scc1 L_g0_job
    s_lshl_b32 s64, s67, 7
    s_add_u32 s64, s64, s68
    s_add_u32 m0, s76, 0
    s_add_u32 s62, s64, 0
    buffer_load_dwordx4 v22, s[4:7], s62 offen lds
    s_add_u32 m0, s76, 1024
    s_add_u32 s62, s64, 7168
    buffer_load_dwordx4 v23, s[4:7], s62 offen lds
    s_add_u32 m0, s76, 2048
    s_add_u32 s62, s64, 14336
    buffer_load_dwordx4 v22, s[4:7], s62 offen lds
    s_add_u32 m0, s76, 3072
    s_add_u32 s62, s64, 21504
    buffer_load_dwordx4 v23, s[4:7], s62 offen lds
    s_mul_i32 s64, s67, 172032
    s_add_u32 s64, s64, s72
    s_add_u32 m0, s77, 65536
    s_add_u32 s64, s64, 896
    buffer_load_dwordx4 v10, s[12:15], s64 offen lds
    s_mul_i32 s64, s67, 57344
    s_add_u32 s64, s64, s73
    s_add_u32 m0, s77, 94208
    s_nop 0
    buffer_load_dwordx4 v16, s[8:11], s64 offen lds
    s_add_u32 s67, s67, 1
    s_cmp_eq_u32 s67, 7
    s_cselect_b32 s67, 0, s67
    s_mov_b32 s20, s50
    s_mov_b32 s21, s51
    s_mov_b32 s22, 896
    s_mov_b32 s23, 0x00020000
    buffer_load_ushort v18, v12, s[20:23], s66 offen
    buffer_load_ushort v20, v13, s[20:23], s66 offen
    s_mov_b32 s20, s36
    s_mov_b32 s21, s37
    s_mov_b32 s22, 25088
    s_mov_b32 s23, 0x00020000
    s_cmp_eq_u32 s28, 0
    s_cselect_b32 s65, s31, s94
    s_mul_i32 s65, s65, 1568
    s_mul_i32 s64, s29, 896
    s_add_u32 s64, s64, s65
    s_add_u32 m0, s77, 151552
    s_nop 0
    buffer_load_dwordx4 v11, s[20:23], s64 offen lds
    s_mov_b32 s16, s56
    s_mov_b32 s17, s57
    s_mov_b32 s18, 268435456
    s_mov_b32 s19, 0x00020000
    s_add_u32 s64, s56, 655360
    s_addc_u32 s65, s57, 0
    s_load_dword s58, s[64:65], 0
    s_barrier
    v_and_b32 v3, 31, v0
    v_bfe_u32 v7, v0, 4, 1
    v_and_b32 v12, 3, v0
    v_lshl_add_u32 v7, v7, 2, v12
    v_cmp_lt_u32 vcc, 5, v7
    v_xor_b32 v12, 1, v7
    s_nop 0
    v_cndmask_b32 v7, v7, v12, vcc
    v_lshlrev_b32 v7, 3, v7
    v_mov_b32 v19, 0
    v_mov_b32 v21, 0
    v_lshrrev_b32 v17, 4, v0
    v_lshlrev_b32 v17, 12, v17
    v_and_b32 v12, 15, v0
    v_lshl_add_u32 v17, v12, 6, v17
    s_add_u32 s64, s77, 94256
    v_add_u32 v17, s64, v17
    v_mov_b32 v240, 0xdddddddd
    v_sub_u32 v242, 1, v4
    v_cvt_f32_u32 v242, v242
    v_lshrrev_b32 v254, 1, v0
    v_lshlrev_b32 v254, 7, v254
    v_and_b32 v12, 1, v0
    v_lshl_add_u32 v254, v12, 4, v254
    s_lshl_b32 s3, s59, 4
    s_add_u32 s3, s3, s95
    s_lshl_b32 s3, s3, 11
    s_add_u32 s3, s3, 3145728
    s_lshl_b32 s60, s93, 1
    s_lshl_b32 s97, s30, 2
    s_add_u32 s97, s97, s60
    s_lshl_b32 s97, s97, 15
    s_lshl_b32 s98, s25, 11
    s_add_u32 s97, s97, s98
    s_add_u32 s97, s97, 3145728
    s_add_u32 s98, s98, 91136
    s_lshl_b32 s99, s30, 11
    s_lshl_b32 s60, s60, 2
    s_add_u32 s99, s99, s60
    s_add_u32 s99, s99, 753792
    s_and_b32 s100, s31, 0
    v_lshrrev_b32 v253, 1, v0
    v_xor_b32 v253, s100, v253
    v_lshlrev_b32 v253, 2, v253
    v_add_u32 v253, s25, v253
    v_lshlrev_b32 v253, 2, v253
    s_mov_b32 s62, 0x67452310
    s_mov_b32 s63, 0xfecdab89
    v_lshrrev_b64 v[12:13], v253, s[62:63]
    v_and_b32 v253, 15, v12
    v_lshlrev_b32 v253, 7, v253
    v_and_b32 v12, 1, v0
    v_lshl_add_u32 v253, v12, 2, v253
    v_mov_b32 v48, 0
    v_mov_b32 v49, 0
    v_mov_b32 v50, 0
    v_mov_b32 v51, 0
    v_mov_b32 v52, 0
    v_mov_b32 v53, 0
    v_mov_b32 v54, 0
    v_mov_b32 v55, 0
    v_mov_b32 v56, 0
    v_mov_b32 v57, 0
    v_mov_b32 v58, 0
    v_mov_b32 v59, 0
    v_mov_b32 v60, 0
    v_mov_b32 v61, 0
    v_mov_b32 v62, 0
    v_mov_b32 v63, 0
    v_mov_b32 v64, 0
    v_mov_b32 v65, 0
    v_mov_b32 v66, 0
    v_mov_b32 v67, 0
    v_mov_b32 v68, 0
    v_mov_b32 v69, 0
    v_mov_b32 v70, 0
    v_mov_b32 v71, 0
    v_mov_b32 v72, 0
    v_mov_b32 v73, 0
    v_mov_b32 v74, 0
    v_mov_b32 v75, 0
    v_mov_b32 v76, 0
    v_mov_b32 v77, 0
    v_mov_b32 v78, 0
    v_mov_b32 v79, 0
    v_mov_b32 v80, 0
    v_mov_b32 v81, 0
    v_mov_b32 v82, 0
    v_mov_b32 v83, 0
    v_mov_b32 v84, 0
    v_mov_b32 v85, 0
    v_mov_b32 v86, 0
    v_mov_b32 v87, 0
    v_mov_b32 v88, 0
    v_mov_b32 v89, 0
    v_mov_b32 v90, 0
    v_mov_b32 v91, 0
    v_mov_b32 v92, 0
    v_mov_b32 v93, 0
    v_mov_b32 v94, 0
    v_mov_b32 v95, 0
    v_mov_b32 v96, 0
    v_mov_b32 v97, 0
    v_mov_b32 v98, 0
    v_mov_b32 v99, 0
    v_mov_b32 v100, 0
    v_mov_b32 v101, 0
    v_mov_b32 v102, 0
    v_mov_b32 v103, 0
    v_mov_b32 v104, 0
    v_mov_b32 v105, 0
    v_mov_b32 v106, 0
    v_mov_b32 v107, 0
    v_mov_b32 v108, 0
    v_mov_b32 v109, 0
    v_mov_b32 v110, 0
    v_mov_b32 v111, 0
    s_waitcnt lgkmcnt(0)
    s_add_u32 s58, s58, 0x9e3779b9
    s_lshl_b32 s64, s67, 7
    s_add_u32 s64, s64, s68
    s_add_u32 m0, s76, 4096
    s_add_u32 s62, s64, 0
    buffer_load_dwordx4 v22, s[4:7], s62 offen lds
    s_add_u32 m0, s76, 5120
    s_add_u32 s62, s64, 7168
    buffer_load_dwordx4 v23, s[4:7], s62 offen lds
    s_add_u32 m0, s76, 6144
    s_add_u32 s62, s64, 14336
    buffer_load_dwordx4 v22, s[4:7], s62 offen lds
    s_add_u32 m0, s76, 7168
    s_add_u32 s62, s64, 21504
    buffer_load_dwordx4 v23, s[4:7], s62 offen lds
    s_mul_i32 s64, s67, 172032
    s_add_u32 s64, s64, s72
    s_add_u32 m0, s77, 69632
    s_add_u32 s64, s64, 896
    buffer_load_dwordx4 v10, s[12:15], s64 offen lds
    s_mul_i32 s64, s67, 57344
    s_add_u32 s64, s64, s73
    s_add_u32 m0, s77, 98304
    s_nop 0
    buffer_load_dwordx4 v16, s[8:11], s64 offen lds
    s_add_u32 s67, s67, 1
    s_cmp_eq_u32 s67, 7
    s_cselect_b32 s67, 0, s67
    s_waitcnt vmcnt(6)
    s_mov_b32 exec_lo, 0xffff
    s_mov_b32 exec_hi, 0x0
    ds_write_b64 v17, v[18:19] offset:0
    s_mov_b64 exec, -1
    s_mov_b64 exec, 1
    ds_add_u32 v5, v6 offset:128
    s_mov_b64 exec, -1
    s_lshl_b32 s64, s67, 7
    s_add_u32 s64, s64, s68
    s_add_u32 m0, s76, 8192
    s_add_u32 s62, s64, 0
    buffer_load_dwordx4 v22, s[4:7], s62 offen lds
    s_add_u32 m0, s76, 9216
    s_add_u32 s62, s64, 7168
    buffer_load_dwordx4 v23, s[4:7], s62 offen lds
    s_add_u32 m0, s76, 10240
    s_add_u32 s62, s64, 14336
    buffer_load_dwordx4 v22, s[4:7], s62 offen lds
    s_add_u32 m0, s76, 11264
    s_add_u32 s62, s64, 21504
    buffer_load_dwordx4 v23, s[4:7], s62 offen lds
    s_mul_i32 s64, s67, 172032
    s_add_u32 s64, s64, s72
    s_add_u32 m0, s77, 73728
    s_add_u32 s64, s64, 896
    buffer_load_dwordx4 v10, s[12:15], s64 offen lds
    s_mul_i32 s64, s67, 57344
    s_add_u32 s64, s64, s73
    s_add_u32 m0, s77, 102400
    s_nop 0
    buffer_load_dwordx4 v16, s[8:11], s64 offen lds
    s_add_u32 s67, s67, 1
    s_cmp_eq_u32 s67, 7
    s_cselect_b32 s67, 0, s67
    s_waitcnt vmcnt(6)
    s_mov_b32 exec_lo, 0xffff0000
    s_mov_b32 exec_hi, 0x0
    ds_write_b64 v17, v[18:19] offset:0
    s_mov_b64 exec, -1
    s_mov_b64 exec, 1
    ds_add_u32 v5, v6 offset:132
    s_mov_b64 exec, -1
    s_lshl_b32 s64, s67, 7
    s_add_u32 s64, s64, s68
    s_add_u32 m0, s76, 12288
    s_add_u32 s62, s64, 0
    buffer_load_dwordx4 v22, s[4:7], s62 offen lds
    s_add_u32 m0, s76, 13312
    s_add_u32 s62, s64, 7168
    buffer_load_dwordx4 v23, s[4:7], s62 offen lds
    s_add_u32 m0, s76, 14336
    s_add_u32 s62, s64, 14336
    buffer_load_dwordx4 v22, s[4:7], s62 offen lds
    s_add_u32 m0, s76, 15360
    s_add_u32 s62, s64, 21504
    buffer_load_dwordx4 v23, s[4:7], s62 offen lds
    s_mul_i32 s64, s67, 172032
    s_add_u32 s64, s64, s72
    s_add_u32 m0, s77, 77824
    s_add_u32 s64, s64, 896
    buffer_load_dwordx4 v10, s[12:15], s64 offen lds
    s_mul_i32 s64, s67, 57344
    s_add_u32 s64, s64, s73
    s_add_u32 m0, s77, 106496
    s_nop 0
    buffer_load_dwordx4 v16, s[8:11], s64 offen lds
    s_add_u32 s67, s67, 1
    s_cmp_eq_u32 s67, 7
    s_cselect_b32 s67, 0, s67
    s_waitcnt vmcnt(6)
    s_mov_b32 exec_lo, 0x0
    s_mov_b32 exec_hi, 0xffff
    ds_write_b64 v17, v[18:19] offset:0
    s_mov_b64 exec, -1
    s_mov_b64 exec, 1
    ds_add_u32 v5, v6 offset:136
    s_mov_b64 exec, -1
    s_mov_b32 s61, 300000
lw_1:
    ds_read_b32 v12, v5 offset:160
    s_waitcnt lgkmcnt(0)
    v_readfirstlane_b32 s60, v12
    s_sub_u32 s61, s61, 1
    s_cbranch_scc1 lwd_2
    s_cmp_ge_u32 s60, 4
    s_cbranch_scc1 lwd_2
    s_branch lw_1
lwd_2:
    s_lshl_b32 s64, s67, 7
    s_add_u32 s64, s64, s68
    s_add_u32 m0, s76, 0
    s_add_u32 s62, s64, 0
    buffer_load_dwordx4 v22, s[4:7], s62 offen lds
    s_add_u32 m0, s76, 1024
    s_add_u32 s62, s64, 7168
    buffer_load_dwordx4 v23, s[4:7], s62 offen lds
    s_add_u32 m0, s76, 2048
    s_add_u32 s62, s64, 14336
    buffer_load_dwordx4 v22, s[4:7], s62 offen lds
    s_add_u32 m0, s76, 3072
    s_add_u32 s62, s64, 21504
    buffer_load_dwordx4 v23, s[4:7], s62 offen lds
    s_mul_i32 s64, s67, 172032
    s_add_u32 s64, s64, s72
    s_add_u32 m0, s77, 81920
    s_add_u32 s64, s64, 896
    buffer_load_dwordx4 v10, s[12:15], s64 offen lds
    s_mul_i32 s64, s67, 57344
    s_add_u32 s64, s64, s73
    s_add_u32 m0, s77, 110592
    s_nop 0
    buffer_load_dwordx4 v16, s[8:11], s64 offen lds
    s_add_u32 s67, s67, 1
    s_cmp_eq_u32 s67, 7
    s_cselect_b32 s67, 0, s67
    s_waitcnt vmcnt(6)
    s_mov_b32 exec_lo, 0x0
    s_mov_b32 exec_hi, 0xffff0000
    ds_write_b64 v17, v[18:19] offset:0
    s_mov_b64 exec, -1
    s_mov_b64 exec, 1
    ds_add_u32 v5, v6 offset:140
    s_mov_b64 exec, -1
    s_mov_b32 s61, 300000
lw_3:
    ds_read_b32 v12, v5 offset:164
    s_waitcnt lgkmcnt(0)
    v_readfirstlane_b32 s60, v12
    s_sub_u32 s61, s61, 1
    s_cbranch_scc1 lwd_4
    s_cmp_ge_u32 s60, 4
    s_cbranch_scc1 lwd_4
    s_branch lw_3
lwd_4:
    s_lshl_b32 s64, s67, 7
    s_add_u32 s64, s64, s68
    s_add_u32 m0, s76, 4096
    s_add_u32 s62, s64, 0
    buffer_load_dwordx4 v22, s[4:7], s62 offen lds
    s_add_u32 m0, s76, 5120
    s_add_u32 s62, s64, 7168
    buffer_load_dwordx4 v23, s[4:7], s62 offen lds
    s_add_u32 m0, s76, 6144
    s_add_u32 s62, s64, 14336
    buffer_load_dwordx4 v22, s[4:7], s62 offen lds
    s_add_u32 m0, s76, 7168
    s_add_u32 s62, s64, 21504
    buffer_load_dwordx4 v23, s[4:7], s62 offen lds
    s_mul_i32 s64, s67, 172032
    s_add_u32 s64, s64, s72
    s_add_u32 m0, s77, 86016
    s_add_u32 s64, s64, 896
    buffer_load_dwordx4 v10, s[12:15], s64 offen lds
    s_mul_i32 s64, s67, 57344
    s_add_u32 s64, s64, s73
    s_add_u32 m0, s77, 114688
    s_nop 0
    buffer_load_dwordx4 v16, s[8:11], s64 offen lds
    s_add_u32 s67, s67, 1
    s_cmp_eq_u32 s67, 7
    s_cselect_b32 s67, 0, s67
    s_waitcnt vmcnt(6)
    s_mov_b32 exec_lo, 0xffff
    s_mov_b32 exec_hi, 0x0
    ds_write_b64 v17, v[20:21] offset:16384
    s_mov_b64 exec, -1
    s_mov_b64 exec, 1
    ds_add_u32 v5, v6 offset:144
    s_mov_b64 exec, -1
    s_mov_b32 s61, 300000
lw_5:
    ds_read_b32 v12, v5 offset:168
    s_waitcnt lgkmcnt(0)
    v_readfirstlane_b32 s60, v12
    s_sub_u32 s61, s61, 1
    s_cbranch_scc1 lwd_6
    s_cmp_ge_u32 s60, 4
    s_cbranch_scc1 lwd_6
    s_branch lw_5
lwd_6:
    s_lshl_b32 s64, s67, 7
    s_add_u32 s64, s64, s68
    s_add_u32 m0, s76, 8192
    s_add_u32 s62, s64, 0
    buffer_load_dwordx4 v22, s[4:7], s62 offen lds
    s_add_u32 m0, s76, 9216
    s_add_u32 s62, s64, 7168
    buffer_load_dwordx4 v23, s[4:7], s62 offen lds
    s_add_u32 m0, s76, 10240
    s_add_u32 s62, s64, 14336
    buffer_load_dwordx4 v22, s[4:7], s62 offen lds
    s_add_u32 m0, s76, 11264
    s_add_u32 s62, s64, 21504
    buffer_load_dwordx4 v23, s[4:7], s62 offen lds
    s_mul_i32 s64, s67, 172032
    s_add_u32 s64, s64, s72
    s_add_u32 m0, s77, 90112
    s_add_u32 s64, s64, 896
    buffer_load_dwordx4 v10, s[12:15], s64 offen lds
    s_mul_i32 s64, s67, 57344
    s_add_u32 s64, s64, s73
    s_add_u32 m0, s77, 118784
    s_nop 0
    buffer_load_dwordx4 v16, s[8:11], s64 offen lds
    s_add_u32 s67, s67, 1
    s_cmp_eq_u32 s67, 7
    s_cselect_b32 s67, 0, s67
    s_waitcnt vmcnt(6)
    s_mov_b32 exec_lo, 0xffff0000
    s_mov_b32 exec_hi, 0x0
    ds_write_b64 v17, v[20:21] offset:16384
    s_mov_b64 exec, -1
    s_mov_b64 exec, 1
    ds_add_u32 v5, v6 offset:148
    s_mov_b64 exec, -1
    s_waitcnt vmcnt(0)
    s_mov_b32 exec_lo, 0x0
    s_mov_b32 exec_hi, 0xffff
    ds_write_b64 v17, v[20:21] offset:16384
    s_mov_b64 exec, -1
    s_mov_b64 exec, 1
    ds_add_u32 v5, v6 offset:152
    s_mov_b64 exec, -1
    s_mul_i32 s64, s67, 172032
    s_add_u32 s64, s64, s72
    s_add_u32 m0, s77, 122880
    s_add_u32 s64, s64, 1792
    buffer_load_dwordx4 v10, s[12:15], s64 offen lds
    s_add_u32 s67, s67, 1
    s_cmp_eq_u32 s67, 7
    s_cselect_b32 s67, 0, s67
    s_mul_i32 s64, s67, 172032
    s_add_u32 s64, s64, s72
    s_add_u32 m0, s77, 126976
    s_add_u32 s64, s64, 1792
    buffer_load_dwordx4 v10, s[12:15], s64 offen lds
    s_add_u32 s67, s67, 1
    s_cmp_eq_u32 s67, 7
    s_cselect_b32 s67, 0, s67
    s_mul_i32 s64, s67, 172032
    s_add_u32 s64, s64, s72
    s_add_u32 m0, s77, 131072
    s_add_u32 s64, s64, 1792
    buffer_load_dwordx4 v10, s[12:15], s64 offen lds
    s_add_u32 s67, s67, 1
    s_cmp_eq_u32 s67, 7
    s_cselect_b32 s67, 0, s67
    s_mul_i32 s64, s67, 172032
    s_add_u32 s64, s64, s72
    s_add_u32 m0, s77, 135168
    s_add_u32 s64, s64, 1792
    buffer_load_dwordx4 v10, s[12:15], s64 offen lds
    s_add_u32 s67, s67, 1
    s_cmp_eq_u32 s67, 7
    s_cselect_b32 s67, 0, s67
    s_mul_i32 s64, s67, 172032
    s_add_u32 s64, s64, s72
    s_add_u32 m0, s77, 139264
    s_add_u32 s64, s64, 1792
    buffer_load_dwordx4 v10, s[12:15], s64 offen lds
    s_add_u32 s67, s67, 1
    s_cmp_eq_u32 s67, 7
    s_cselect_b32 s67, 0, s67
    s_mul_i32 s64, s67, 172032
    s_add_u32 s64, s64, s72
    s_add_u32 m0, s77, 143360
    s_add_u32 s64, s64, 1792
    buffer_load_dwordx4 v10, s[12:15], s64 offen lds
    s_add_u32 s67, s67, 1
    s_cmp_eq_u32 s67, 7
    s_cselect_b32 s67, 0, s67
    s_mul_i32 s64, s67, 172032
    s_add_u32 s64, s64, s72
    s_add_u32 m0, s77, 147456
    s_add_u32 s64, s64, 1792
    buffer_load_dwordx4 v10, s[12:15], s64 offen lds
    s_add_u32 s67, s67, 1
    s_cmp_eq_u32 s67, 7
    s_cselect_b32 s67, 0, s67
    s_branch L_g0_k2
L_g0_job:
    s_cmp_eq_u32 s26, 1
    s_cselect_b32 s84, s44, s46
    s_cselect_b32 s85, s45, s47
    s_mov_b32 s86, 25088
    s_mov_b32 s87, 0x00020000
    s_lshl_b32 s64, s67, 7
    s_add_u32 s64, s64, s68
    s_add_u32 m0, s76, 0
    s_add_u32 s62, s64, 0
    buffer_load_dwordx4 v22, s[4:7], s62 offen lds
    s_add_u32 m0, s76, 1024
    s_add_u32 s62, s64, 7168
    buffer_load_dwordx4 v23, s[4:7], s62 offen lds
    s_add_u32 m0, s76, 2048
    s_add_u32 s62, s64, 14336
    buffer_load_dwordx4 v22, s[4:7], s62 offen lds
    s_add_u32 m0, s76, 3072
    s_add_u32 s62, s64, 21504
    buffer_load_dwordx4 v23, s[4:7], s62 offen lds
    s_mul_i32 s64, s67, 3584
    s_add_u32 s64, s64, s74
    s_add_u32 m0, s77, 122880
    s_mov_b32 exec_hi, 0x00ffffff
    buffer_load_dwordx4 v2, s[84:87], s64 offen lds
    s_mov_b32 exec_hi, -1
    s_add_u32 s67, s67, 1
    s_cmp_eq_u32 s67, 7
    s_cselect_b32 s67, 0, s67
    s_mov_b32 s20, s50
    s_mov_b32 s21, s51
    s_mov_b32 s22, 896
    s_mov_b32 s23, 0x00020000
    buffer_load_ushort v18, v12, s[20:23], s66 offen
    buffer_load_ushort v20, v13, s[20:23], s66 offen
    s_mov_b32 s20, s36
    s_mov_b32 s21, s37
    s_mov_b32 s22, 25088
    s_mov_b32 s23, 0x00020000
    s_cmp_eq_u32 s28, 0
    s_cselect_b32 s65, s31, s94
    s_mul_i32 s65, s65, 1568
    s_mul_i32 s64, s29, 896
    s_add_u32 s64, s64, s65
    s_add_u32 m0, s77, 151552
    s_nop 0
    buffer_load_dwordx4 v11, s[20:23], s64 offen lds
    s_mov_b32 s16, s56
    s_mov_b32 s17, s57
    s_mov_b32 s18, 268435456
    s_mov_b32 s19, 0x00020000
    s_add_u32 s64, s56, 655360
    s_addc_u32 s65, s57, 0
    s_load_dword s58, s[64:65], 0
    s_barrier
    v_and_b32 v3, 31, v0
    v_bfe_u32 v7, v0, 4, 1
    v_and_b32 v12, 3, v0
    v_lshl_add_u32 v7, v7, 2, v12
    v_cmp_lt_u32 vcc, 5, v7
    v_xor_b32 v12, 1, v7
    s_nop 0
    v_cndmask_b32 v7, v7, v12, vcc
    v_lshlrev_b32 v7, 3, v7
    v_mov_b32 v19, 0
    v_mov_b32 v21, 0
    v_lshrrev_b32 v17, 4, v0
    v_lshlrev_b32 v17, 12, v17
    v_and_b32 v12, 15, v0
    v_lshl_add_u32 v17, v12, 6, v17
    s_add_u32 s64, s77, 94256
    v_add_u32 v17, s64, v17
    v_mov_b32 v240, 0xdddddddd
    v_sub_u32 v242, 1, v4
    v_cvt_f32_u32 v242, v242
    v_lshrrev_b32 v254, 1, v0
    v_lshlrev_b32 v254, 7, v254
    v_and_b32 v12, 1, v0
    v_lshl_add_u32 v254, v12, 4, v254
    s_lshl_b32 s3, s59, 4
    s_add_u32 s3, s3, s95
    s_lshl_b32 s3, s3, 11
    s_add_u32 s3, s3, 3145728
    s_lshl_b32 s60, s93, 1
    s_lshl_b32 s97, s30, 2
    s_add_u32 s97, s97, s60
    s_lshl_b32 s97, s97, 15
    s_lshl_b32 s98, s25, 11
    s_add_u32 s97, s97, s98
    s_add_u32 s97, s97, 3145728
    s_add_u32 s98, s98, 91136
    s_lshl_b32 s99, s30, 11
    s_lshl_b32 s60, s60, 2
    s_add_u32 s99, s99, s60
    s_add_u32 s99, s99, 753792
    s_and_b32 s100, s31, 0
    v_lshrrev_b32 v253, 1, v0
    v_xor_b32 v253, s100, v253
    v_lshlrev_b32 v253, 2, v253
    v_add_u32 v253, s25, v253
    v_lshlrev_b32 v253, 2, v253
    s_mov_b32 s62, 0x67452310
    s_mov_b32 s63, 0xfecdab89
    v_lshrrev_b64 v[12:13], v253, s[62:63]
    v_and_b32 v253, 15, v12
    v_lshlrev_b32 v253, 7, v253
    v_and_b32 v12, 1, v0
    v_lshl_add_u32 v253, v12, 2, v253
    v_mov_b32 v48, 0
    v_mov_b32 v49, 0
    v_mov_b32 v50, 0
    v_mov_b32 v51, 0
    v_mov_b32 v52, 0
    v_mov_b32 v53, 0
    v_mov_b32 v54, 0
    v_mov_b32 v55, 0
    v_mov_b32 v56, 0
    v_mov_b32 v57, 0
    v_mov_b32 v58, 0
    v_mov_b32 v59, 0
    v_mov_b32 v60, 0
    v_mov_b32 v61, 0
    v_mov_b32 v62, 0
    v_mov_b32 v63, 0
    v_mov_b32 v64, 0
    v_mov_b32 v65, 0
    v_mov_b32 v66, 0
    v_mov_b32 v67, 0
    v_mov_b32 v68, 0
    v_mov_b32 v69, 0
    v_mov_b32 v70, 0
    v_mov_b32 v71, 0
    v_mov_b32 v72, 0
    v_mov_b32 v73, 0
    v_mov_b32 v74, 0
    v_mov_b32 v75, 0
    v_mov_b32 v76, 0
    v_mov_b32 v77, 0
    v_mov_b32 v78, 0
    v_mov_b32 v79, 0
    v_mov_b32 v80, 0
    v_mov_b32 v81, 0
    v_mov_b32 v82, 0
    v_mov_b32 v83, 0
    v_mov_b32 v84, 0
    v_mov_b32 v85, 0
    v_mov_b32 v86, 0
    v_mov_b32 v87, 0
    v_mov_b32 v88, 0
    v_mov_b32 v89, 0
    v_mov_b32 v90, 0
    v_mov_b32 v91, 0
    v_mov_b32 v92, 0
    v_mov_b32 v93, 0
    v_mov_b32 v94, 0
    v_mov_b32 v95, 0
    v_mov_b32 v96, 0
    v_mov_b32 v97, 0
    v_mov_b32 v98, 0
    v_mov_b32 v99, 0
    v_mov_b32 v100, 0
    v_mov_b32 v101, 0
    v_mov_b32 v102, 0
    v_mov_b32 v103, 0
    v_mov_b32 v104, 0
    v_mov_b32 v105, 0
    v_mov_b32 v106, 0
    v_mov_b32 v107, 0
    v_mov_b32 v108, 0
    v_mov_b32 v109, 0
    v_mov_b32 v110, 0
    v_mov_b32 v111, 0
    s_waitcnt lgkmcnt(0)
    s_add_u32 s58, s58, 0x9e3779b9
    s_lshl_b32 s64, s67, 7
    s_add_u32 s64, s64, s68
    s_add_u32 m0, s76, 4096
    s_add_u32 s62, s64, 0
    buffer_load_dwordx4 v22, s[4:7], s62 offen lds
    s_add_u32 m0, s76, 5120
    s_add_u32 s62, s64, 7168
    buffer_load_dwordx4 v23, s[4:7], s62 offen lds
    s_add_u32 m0, s76, 6144
    s_add_u32 s62, s64, 14336
    buffer_load_dwordx4 v22, s[4:7], s62 offen lds
    s_add_u32 m0, s76, 7168
    s_add_u32 s62, s64, 21504
    buffer_load_dwordx4 v23, s[4:7], s62 offen lds
    s_mul_i32 s64, s67, 3584
    s_add_u32 s64, s64, s74
    s_add_u32 m0, s77, 126976
    s_mov_b32 exec_hi, 0x00ffffff
    buffer_load_dwordx4 v2, s[84:87], s64 offen lds
    s_mov_b32 exec_hi, -1
    s_add_u32 s67, s67, 1
    s_cmp_eq_u32 s67, 7
    s_cselect_b32 s67, 0, s67
    s_waitcnt vmcnt(5)
    s_mov_b64 exec, 1
    ds_add_u32 v5, v6 offset:128
    s_mov_b64 exec, -1
    s_lshl_b32 s64, s67, 7
    s_add_u32 s64, s64, s68
    s_add_u32 m0, s76, 8192
    s_add_u32 s62, s64, 0
    buffer_load_dwordx4 v22, s[4:7], s62 offen lds
    s_add_u32 m0, s76, 9216
    s_add_u32 s62, s64, 7168
    buffer_load_dwordx4 v23, s[4:7], s62 offen lds
    s_add_u32 m0, s76, 10240
    s_add_u32 s62, s64, 14336
    buffer_load_dwordx4 v22, s[4:7], s62 offen lds
    s_add_u32 m0, s76, 11264
    s_add_u32 s62, s64, 21504
    buffer_load_dwordx4 v23, s[4:7], s62 offen lds
    s_mul_i32 s64, s67, 3584
    s_add_u32 s64, s64, s74
    s_add_u32 m0, s77, 131072
    s_mov_b32 exec_hi, 0x00ffffff
    buffer_load_dwordx4 v2, s[84:87], s64 offen lds
    s_mov_b32 exec_hi, -1
    s_add_u32 s67, s67, 1
    s_cmp_eq_u32 s67, 7
    s_cselect_b32 s67, 0, s67
    s_waitcnt vmcnt(5)
    s_mov_b64 exec, 1
    ds_add_u32 v5, v6 offset:132
    s_mov_b64 exec, -1
    s_lshl_b32 s64, s67, 7
    s_add_u32 s64, s64, s68
    s_add_u32 m0, s76, 12288
    s_add_u32 s62, s64, 0
    buffer_load_dwordx4 v22, s[4:7], s62 offen lds
    s_add_u32 m0, s76, 13312
    s_add_u32 s62, s64, 7168
    buffer_load_dwordx4 v23, s[4:7], s62 offen lds
    s_add_u32 m0, s76, 14336
    s_add_u32 s62, s64, 14336
    buffer_load_dwordx4 v22, s[4:7], s62 offen lds
    s_add_u32 m0, s76, 15360
    s_add_u32 s62, s64, 21504
    buffer_load_dwordx4 v23, s[4:7], s62 offen lds
    s_mul_i32 s64, s67, 3584
    s_add_u32 s64, s64, s74
    s_add_u32 m0, s77, 135168
    s_mov_b32 exec_hi, 0x00ffffff
    buffer_load_dwordx4 v2, s[84:87], s64 offen lds
    s_mov_b32 exec_hi, -1
    s_add_u32 s67, s67, 1
    s_cmp_eq_u32 s67, 7
    s_cselect_b32 s67, 0, s67
    s_waitcnt vmcnt(5)
    s_mov_b64 exec, 1
    ds_add_u32 v5, v6 offset:136
    s_mov_b64 exec, -1
    s_mov_b32 s61, 300000
lw_7:
    ds_read_b32 v12, v5 offset:160
    s_waitcnt lgkmcnt(0)
    v_readfirstlane_b32 s60, v12
    s_sub_u32 s61, s61, 1
    s_cbranch_scc1 lwd_8
    s_cmp_ge_u32 s60, 4
    s_cbranch_scc1 lwd_8
    s_branch lw_7
lwd_8:
    s_lshl_b32 s64, s67, 7
    s_add_u32 s64, s64, s68
    s_add_u32 m0, s76, 0
    s_add_u32 s62, s64, 0
    buffer_load_dwordx4 v22, s[4:7], s62 offen lds
    s_add_u32 m0, s76, 1024
    s_add_u32 s62, s64, 7168
    buffer_load_dwordx4 v23, s[4:7], s62 offen lds
    s_add_u32 m0, s76, 2048
    s_add_u32 s62, s64, 14336
    buffer_load_dwordx4 v22, s[4:7], s62 offen lds
    s_add_u32 m0, s76, 3072
    s_add_u32 s62, s64, 21504
    buffer_load_dwordx4 v23, s[4:7], s62 offen lds
    s_mul_i32 s64, s67, 3584
    s_add_u32 s64, s64, s74
    s_add_u32 m0, s77, 139264
    s_mov_b32 exec_hi, 0x00ffffff
    buffer_load_dwordx4 v2, s[84:87], s64 offen lds
    s_mov_b32 exec_hi, -1
    s_add_u32 s67, s67, 1
    s_cmp_eq_u32 s67, 7
    s_cselect_b32 s67, 0, s67
    s_waitcnt vmcnt(5)
    s_mov_b64 exec, 1
    ds_add_u32 v5, v6 offset:140
    s_mov_b64 exec, -1
    s_mov_b32 s61, 300000
lw_9:
    ds_read_b32 v12, v5 offset:164
    s_waitcnt lgkmcnt(0)
    v_readfirstlane_b32 s60, v12
    s_sub_u32 s61, s61, 1
    s_cbranch_scc1 lwd_10
    s_cmp_ge_u32 s60, 4
    s_cbranch_scc1 lwd_10
    s_branch lw_9
lwd_10:
    s_lshl_b32 s64, s67, 7
    s_add_u32 s64, s64, s68
    s_add_u32 m0, s76, 4096
    s_add_u32 s62, s64, 0
    buffer_load_dwordx4 v22, s[4:7], s62 offen lds
    s_add_u32 m0, s76, 5120
    s_add_u32 s62, s64, 7168
    buffer_load_dwordx4 v23, s[4:7], s62 offen lds
    s_add_u32 m0, s76, 6144
    s_add_u32 s62, s64, 14336
    buffer_load_dwordx4 v22, s[4:7], s62 offen lds
    s_add_u32 m0, s76, 7168
    s_add_u32 s62, s64, 21504
    buffer_load_dwordx4 v23, s[4:7], s62 offen lds
    s_mul_i32 s64, s67, 3584
    s_add_u32 s64, s64, s74
    s_add_u32 m0, s77, 143360
    s_mov_b32 exec_hi, 0x00ffffff
    buffer_load_dwordx4 v2, s[84:87], s64 offen lds
    s_mov_b32 exec_hi, -1
    s_add_u32 s67, s67, 1
    s_cmp_eq_u32 s67, 7
    s_cselect_b32 s67, 0, s67
    s_waitcnt vmcnt(5)
    s_mov_b64 exec, 1
    ds_add_u32 v5, v6 offset:144
    s_mov_b64 exec, -1
    s_mov_b32 s61, 300000
lw_11:
    ds_read_b32 v12, v5 offset:168
    s_waitcnt lgkmcnt(0)
    v_readfirstlane_b32 s60, v12
    s_sub_u32 s61, s61, 1
    s_cbranch_scc1 lwd_12
    s_cmp_ge_u32 s60, 4
    s_cbranch_scc1 lwd_12
    s_branch lw_11
lwd_12:
    s_lshl_b32 s64, s67, 7
    s_add_u32 s64, s64, s68
    s_add_u32 m0, s76, 8192
    s_add_u32 s62, s64, 0
    buffer_load_dwordx4 v22, s[4:7], s62 offen lds
    s_add_u32 m0, s76, 9216
    s_add_u32 s62, s64, 7168
    buffer_load_dwordx4 v23, s[4:7], s62 offen lds
    s_add_u32 m0, s76, 10240
    s_add_u32 s62, s64, 14336
    buffer_load_dwordx4 v22, s[4:7], s62 offen lds
    s_add_u32 m0, s76, 11264
    s_add_u32 s62, s64, 21504
    buffer_load_dwordx4 v23, s[4:7], s62 offen lds
    s_mul_i32 s64, s67, 3584
    s_add_u32 s64, s64, s74
    s_add_u32 m0, s77, 147456
    s_mov_b32 exec_hi, 0x00ffffff
    buffer_load_dwordx4 v2, s[84:87], s64 offen lds
    s_mov_b32 exec_hi, -1
    s_add_u32 s67, s67, 1
    s_cmp_eq_u32 s67, 7
    s_cselect_b32 s67, 0, s67
    s_waitcnt vmcnt(5)
    s_mov_b64 exec, 1
    ds_add_u32 v5, v6 offset:148
    s_mov_b64 exec, -1
    s_waitcnt vmcnt(0)
    s_mov_b64 exec, 1
    ds_add_u32 v5, v6 offset:152
    s_mov_b64 exec, -1
    s_mul_i32 s64, s67, 172032
    s_add_u32 s64, s64, s72
    s_add_u32 m0, s77, 65536
    s_add_u32 s64, s64, 896
    buffer_load_dwordx4 v10, s[12:15], s64 offen lds
    s_add_u32 s67, s67, 1
    s_cmp_eq_u32 s67, 7
    s_cselect_b32 s67, 0, s67
    s_mul_i32 s64, s67, 172032
    s_add_u32 s64, s64, s72
    s_add_u32 m0, s77, 69632
    s_add_u32 s64, s64, 896
    buffer_load_dwordx4 v10, s[12:15], s64 offen lds
    s_add_u32 s67, s67, 1
    s_cmp_eq_u32 s67, 7
    s_cselect_b32 s67, 0, s67
    s_mul_i32 s64, s67, 172032
    s_add_u32 s64, s64, s72
    s_add_u32 m0, s77, 73728
    s_add_u32 s64, s64, 896
    buffer_load_dwordx4 v10, s[12:15], s64 offen lds
    s_add_u32 s67, s67, 1
    s_cmp_eq_u32 s67, 7
    s_cselect_b32 s67, 0, s67
    s_mul_i32 s64, s67, 172032
    s_add_u32 s64, s64, s72
    s_add_u32 m0, s77, 77824
    s_add_u32 s64, s64, 896
    buffer_load_dwordx4 v10, s[12:15], s64 offen lds
    s_add_u32 s67, s67, 1
    s_cmp_eq_u32 s67, 7
    s_cselect_b32 s67, 0, s67
    s_mul_i32 s64, s67, 172032
    s_add_u32 s64, s64, s72
    s_add_u32 m0, s77, 81920
    s_add_u32 s64, s64, 896
    buffer_load_dwordx4 v10, s[12:15], s64 offen lds
    s_add_u32 s67, s67, 1
    s_cmp_eq_u32 s67, 7
    s_cselect_b32 s67, 0, s67
    s_mul_i32 s64, s67, 172032
    s_add_u32 s64, s64, s72
    s_add_u32 m0, s77, 86016
    s_add_u32 s64, s64, 896
    buffer_load_dwordx4 v10, s[12:15], s64 offen lds
    s_add_u32 s67, s67, 1
    s_cmp_eq_u32 s67, 7
    s_cselect_b32 s67, 0, s67
    s_mul_i32 s64, s67, 172032
    s_add_u32 s64, s64, s72
    s_add_u32 m0, s77, 90112
    s_add_u32 s64, s64, 896
    buffer_load_dwordx4 v10, s[12:15], s64 offen lds
    s_add_u32 s67, s67, 1
    s_cmp_eq_u32 s67, 7
    s_cselect_b32 s67, 0, s67
    s_waitcnt vmcnt(0)
    s_mov_b64 exec, 1
    ds_add_u32 v5, v6 offset:64
    s_mov_b64 exec, -1
    s_mov_b32 s61, 300000
lw_13:
    ds_read_b32 v12, v5 offset:100
    s_waitcnt lgkmcnt(0)
    v_readfirstlane_b32 s60, v12
    s_sub_u32 s61, s61, 1
    s_cbranch_scc1 lwd_14
    s_cmp_ge_u32 s60, 4
    s_cbranch_scc1 lwd_14
    s_branch lw_13
lwd_14:
    s_mul_i32 s64, s67, 57344
    s_add_u32 s64, s64, s73
    s_add_u32 m0, s77, 94208
    s_nop 0
    buffer_load_dwordx4 v16, s[8:11], s64 offen lds
    s_add_u32 s67, s67, 1
    s_cmp_eq_u32 s67, 7
    s_cselect_b32 s67, 0, s67
    s_mul_i32 s64, s67, 57344
    s_add_u32 s64, s64, s73
    s_add_u32 m0, s77, 98304
    s_nop 0
    buffer_load_dwordx4 v16, s[8:11], s64 offen lds
    s_add_u32 s67, s67, 1
    s_cmp_eq_u32 s67, 7
    s_cselect_b32 s67, 0, s67
    s_mul_i32 s64, s67, 57344
    s_add_u32 s64, s64, s73
    s_add_u32 m0, s77, 102400
    s_nop 0
    buffer_load_dwordx4 v16, s[8:11], s64 offen lds
    s_add_u32 s67, s67, 1
    s_cmp_eq_u32 s67, 7
    s_cselect_b32 s67, 0, s67
    s_mul_i32 s64, s67, 57344
    s_add_u32 s64, s64, s73
    s_add_u32 m0, s77, 106496
    s_nop 0
    buffer_load_dwordx4 v16, s[8:11], s64 offen lds
    s_add_u32 s67, s67, 1
    s_cmp_eq_u32 s67, 7
    s_cselect_b32 s67, 0, s67
    s_mul_i32 s64, s67, 57344
    s_add_u32 s64, s64, s73
    s_add_u32 m0, s77, 110592
    s_nop 0
    buffer_load_dwordx4 v16, s[8:11], s64 offen lds
    s_add_u32 s67, s67, 1
    s_cmp_eq_u32 s67, 7
    s_cselect_b32 s67, 0, s67
    s_mul_i32 s64, s67, 57344
    s_add_u32 s64, s64, s73
    s_add_u32 m0, s77, 114688
    s_nop 0
    buffer_load_dwordx4 v16, s[8:11], s64 offen lds
    s_add_u32 s67, s67, 1
    s_cmp_eq_u32 s67, 7
    s_cselect_b32 s67, 0, s67
    s_mul_i32 s64, s67, 57344
    s_add_u32 s64, s64, s73
    s_add_u32 m0, s77, 118784
    s_nop 0
    buffer_load_dwordx4 v16, s[8:11], s64 offen lds
    s_add_u32 s67, s67, 1
    s_cmp_eq_u32 s67, 7
    s_cselect_b32 s67, 0, s67
    s_waitcnt vmcnt(0)
    s_mov_b32 exec_lo, 0xffff
    s_mov_b32 exec_hi, 0x0
    ds_write_b64 v17, v[18:19] offset:0
    s_mov_b64 exec, -1
    s_mov_b32 exec_lo, 0xffff0000
    s_mov_b32 exec_hi, 0x0
    ds_write_b64 v17, v[18:19] offset:0
    s_mov_b64 exec, -1
    s_mov_b32 exec_lo, 0x0
    s_mov_b32 exec_hi, 0xffff
    ds_write_b64 v17, v[18:19] offset:0
    s_mov_b64 exec, -1
    s_mov_b32 exec_lo, 0x0
    s_mov_b32 exec_hi, 0xffff0000
    ds_write_b64 v17, v[18:19] offset:0
    s_mov_b64 exec, -1
    s_mov_b32 exec_lo, 0xffff
    s_mov_b32 exec_hi, 0x0
    ds_write_b64 v17, v[20:21] offset:16384
    s_mov_b64 exec, -1
    s_mov_b32 exec_lo, 0xffff0000
    s_mov_b32 exec_hi, 0x0
    ds_write_b64 v17, v[20:21] offset:16384
    s_mov_b64 exec, -1
    s_mov_b32 exec_lo, 0x0
    s_mov_b32 exec_hi, 0xffff
    ds_write_b64 v17, v[20:21] offset:16384
    s_mov_b64 exec, -1
    s_mov_b64 exec, 1
    ds_add_u32 v5, v6 offset:68
    s_mov_b64 exec, -1
    s_mul_i32 s64, s67, 172032
    s_add_u32 s64, s64, s72
    s_add_u32 m0, s77, 122880
    s_add_u32 s64, s64, 1792
    buffer_load_dwordx4 v10, s[12:15], s64 offen lds
    s_add_u32 s67, s67, 1
    s_cmp_eq_u32 s67, 7
    s_cselect_b32 s67, 0, s67
    s_mul_i32 s64, s67, 172032
    s_add_u32 s64, s64, s72
    s_add_u32 m0, s77, 126976
    s_add_u32 s64, s64, 1792
    buffer_load_dwordx4 v10, s[12:15], s64 offen lds
    s_add_u32 s67, s67, 1
    s_cmp_eq_u32 s67, 7
    s_cselect_b32 s67, 0, s67
    s_mul_i32 s64, s67, 172032
    s_add_u32 s64, s64, s72
    s_add_u32 m0, s77, 131072
    s_add_u32 s64, s64, 1792
    buffer_load_dwordx4 v10, s[12:15], s64 offen lds
    s_add_u32 s67, s67, 1
    s_cmp_eq_u32 s67, 7
    s_cselect_b32 s67, 0, s67
    s_mul_i32 s64, s67, 172032
    s_add_u32 s64, s64, s72
    s_add_u32 m0, s77, 135168
    s_add_u32 s64, s64, 1792
    buffer_load_dwordx4 v10, s[12:15], s64 offen lds
    s_add_u32 s67, s67, 1
    s_cmp_eq_u32 s67, 7
    s_cselect_b32 s67, 0, s67
    s_mul_i32 s64, s67, 172032
    s_add_u32 s64, s64, s72
    s_add_u32 m0, s77, 139264
    s_add_u32 s64, s64, 1792
    buffer_load_dwordx4 v10, s[12:15], s64 offen lds
    s_add_u32 s67, s67, 1
    s_cmp_eq_u32 s67, 7
    s_cselect_b32 s67, 0, s67
    s_mul_i32 s64, s67, 172032
    s_add_u32 s64, s64, s72
    s_add_u32 m0, s77, 143360
    s_add_u32 s64, s64, 1792
    buffer_load_dwordx4 v10, s[12:15], s64 offen lds
    s_add_u32 s67, s67, 1
    s_cmp_eq_u32 s67, 7
    s_cselect_b32 s67, 0, s67
    s_mul_i32 s64, s67, 172032
    s_add_u32 s64, s64, s72
    s_add_u32 m0, s77, 147456
    s_add_u32 s64, s64, 1792
    buffer_load_dwordx4 v10, s[12:15], s64 offen lds
    s_add_u32 s67, s67, 1
    s_cmp_eq_u32 s67, 7
    s_cselect_b32 s67, 0, s67
L_g0_k2:
    s_mov_b32 s61, 300000
lw_15:
    ds_read_b32 v12, v5 offset:172
    s_waitcnt lgkmcnt(0)
    v_readfirstlane_b32 s60, v12
    s_sub_u32 s61, s61, 1
    s_cbranch_scc1 lwd_16
    s_cmp_ge_u32 s60, 4
    s_cbranch_scc1 lwd_16
    s_branch lw_15
lwd_16:
    v_bfe_u32 v248, v0, 2, 2
    v_lshl_add_u32 v248, v4, 2, v248
    v_lshlrev_b32 v248, 6, v248
    v_add_u32 v248, v248, v7
    v_add_u32 v248, 151552, v248
    ds_read_b64_tr_b16 v[200:201], v248 offset:0
    ds_read_b64_tr_b16 v[202:203], v248 offset:512
    ds_read_b64_tr_b16 v[204:205], v248 offset:1024
    ds_read_b64_tr_b16 v[206:207], v248 offset:1536
    s_add_u32 s65, s76, 12288
    v_add_u32 v14, s65, v2
    s_mul_i32 s64, s25, 5120
    s_add_u32 s65, s64, 65536
    v_mul_u32_u24 v252, 80, v3
    v_lshl_add_u32 v252, v4, 5, v252
    v_add_u32 v252, s65, v252
    s_lshl_b32 s83, s25, 16
    s_add_u32 s83, s83, 0
    s_mov_b32 s82, 0
    s_mov_b32 s78, 4
    s_mov_b32 s71, 0
    v_mov_b32 v255, s58
    s_lshl_b32 s74, s79, 7
    s_lshl_b32 s60, s25, 2
    s_add_u32 s74, s74, s60
    s_add_u32 s74, s74, 753792
    s_add_u32 s64, s25, 1
    s_and_b32 s64, s64, 3
    s_mul_i32 s64, s64, 12288
    s_add_u32 s64, s64, 91136
    v_add_u32 v8, s64, v2
    s_add_u32 s64, s25, 2
    s_and_b32 s64, s64, 3
    s_mul_i32 s64, s64, 12288
    s_add_u32 s64, s64, 95232
    v_add_u32 v9, s64, v2
    s_add_u32 s64, s25, 3
    s_and_b32 s64, s64, 3
    s_mul_i32 s64, s64, 12288
    s_add_u32 s64, s64, 99328
    v_add_u32 v10, s64, v2
    s_mul_i32 s64, s25, 12288
    s_add_u32 s64, s64, 91136
    v_add_u32 v11, s64, v2
    v_mov_b32 v236, 0
    v_mov_b32 v237, 0
    v_mov_b32 v238, 0
    v_mov_b32 v239, 0
    v_lshl_add_u32 v13, s25, 2, v5
    s_mov_b32 s61, 300000
lw_17:
    ds_read_b32 v12, v13 offset:176
    s_waitcnt lgkmcnt(0)
    v_readfirstlane_b32 s60, v12
    s_sub_u32 s61, s61, 1
    s_cbranch_scc1 lwd_18
    s_cmp_ge_u32 s60, 1
    s_cbranch_scc1 lwd_18
    s_branch lw_17
lwd_18:
    ds_read_b128 v[192:195], v14
    ds_read_b128 v[196:199], v14 offset:1024
    s_mov_b32 exec_lo, 0
    v_mov_b32 v206, 0
    v_mov_b32 v207, 0
    s_mov_b32 exec_lo, -1
    s_waitcnt lgkmcnt(0)
    v_mfma_f32_32x32x16_bf16 v[112:127], v[200:203], v[192:195], 0
    v_mfma_f32_32x32x16_bf16 v[112:127], v[204:207], v[196:199], v[112:127]
    s_nop 11
    v_max3_f32 v248, v112, v113, v114
    v_min3_f32 v249, v112, v113, v114
    v_max3_f32 v248, v248, v115, v116
    v_min3_f32 v249, v249, v115, v116
    v_max3_f32 v248, v248, v117, v118
    v_min3_f32 v249, v249, v117, v118
    v_max3_f32 v248, v248, v119, v120
    v_min3_f32 v249, v249, v119, v120
    v_max3_f32 v248, v248, v121, v122
    v_min3_f32 v249, v249, v121, v122
    v_max3_f32 v248, v248, v123, v124
    v_min3_f32 v249, v249, v123, v124
    v_max3_f32 v248, v248, v125, v126
    v_min3_f32 v249, v249, v125, v126
    v_max_f32 v248, v248, v127
    v_min_f32 v249, v249, v127
    v_mov_b32 v250, v248
    v_mov_b32 v251, v249
    s_nop 0
    v_permlane32_swap_b32 v248, v250
    v_permlane32_swap_b32 v249, v251
    v_max_f32 v248, v248, v250
    v_min_f32 v249, v249, v251
    v_mul_f32 v248, s80, v248
    v_mul_f32 v249, s80, v249
    v_fma_f32 v128, v112, s80, -v248
    v_fma_f32 v144, -v112, s80, v249
    v_fma_f32 v129, v113, s80, -v248
    v_fma_f32 v145, -v113, s80, v249
    v_fma_f32 v130, v114, s80, -v248
    v_fma_f32 v146, -v114, s80, v249
    v_fma_f32 v131, v115, s80, -v248
    v_fma_f32 v147, -v115, s80, v249
    v_fma_f32 v132, v116, s80, -v248
    v_fma_f32 v148, -v116, s80, v249
    v_fma_f32 v133, v117, s80, -v248
    v_fma_f32 v149, -v117, s80, v249
    v_fma_f32 v134, v118, s80, -v248
    v_fma_f32 v150, -v118, s80, v249
    v_fma_f32 v135, v119, s80, -v248
    v_fma_f32 v151, -v119, s80, v249
    v_fma_f32 v136, v120, s80, -v248
    v_fma_f32 v152, -v120, s80, v249
    v_fma_f32 v137, v121, s80, -v248
    v_fma_f32 v153, -v121, s80, v249
    v_fma_f32 v138, v122, s80, -v248
    v_fma_f32 v154, -v122, s80, v249
    v_fma_f32 v139, v123, s80, -v248
    v_fma_f32 v155, -v123, s80, v249
    v_fma_f32 v140, v124, s80, -v248
    v_fma_f32 v156, -v124, s80, v249
    v_fma_f32 v141, v125, s80, -v248
    v_fma_f32 v157, -v125, s80, v249
    v_fma_f32 v142, v126, s80, -v248
    v_fma_f32 v158, -v126, s80, v249
    v_fma_f32 v143, v127, s80, -v248
    v_fma_f32 v159, -v127, s80, v249
    s_waitcnt vmcnt(0)
    s_mov_b64 exec, 1
    ds_add_u32 v5, v6 offset:72
    s_mov_b64 exec, -1
    v_exp_f32 v128, v128
    v_exp_f32 v144, v144
    v_exp_f32 v129, v129
    v_exp_f32 v145, v145
    v_exp_f32 v130, v130
    v_exp_f32 v146, v146
    v_exp_f32 v131, v131
    v_exp_f32 v147, v147
    v_exp_f32 v132, v132
    v_exp_f32 v148, v148
    v_exp_f32 v133, v133
    v_exp_f32 v149, v149
    v_exp_f32 v134, v134
    v_exp_f32 v150, v150
    v_exp_f32 v135, v135
    v_exp_f32 v151, v151
    v_exp_f32 v136, v136
    v_exp_f32 v152, v152
    v_exp_f32 v137, v137
    v_exp_f32 v153, v153
    v_exp_f32 v138, v138
    v_exp_f32 v154, v154
    v_exp_f32 v139, v139
    v_exp_f32 v155, v155
    v_exp_f32 v140, v140
    v_exp_f32 v156, v156
    v_exp_f32 v141, v141
    v_exp_f32 v157, v157
    v_exp_f32 v142, v142
    v_exp_f32 v158, v158
    v_exp_f32 v143, v143
    v_exp_f32 v159, v159
    s_cmp_lg_u32 s25, 0
    s_cbranch_scc1 nopeek_19
    s_mov_b32 s60, 655488
    buffer_load_dwordx4 v[244:247], v254, s[16:19], s60 offen sc1
nopeek_19:
    s_mov_b32 s61, 300000
lw_20:
    ds_read_b32 v12, v5 offset:4
    s_waitcnt lgkmcnt(0)
    v_readfirstlane_b32 s60, v12
    s_sub_u32 s61, s61, 1
    s_cbranch_scc1 lwd_21
    s_cmp_ge_u32 s60, 4
    s_cbranch_scc1 lwd_21
    s_branch lw_20
lwd_21:
    v_add_f32 v250, v140, v141
    v_add_f32 v251, v156, v157
    v_add_f32 v248, v128, v129
    v_add_f32 v249, v144, v145
    v_add_f32 v250, v250, v142
    v_add_f32 v251, v251, v158
    v_add_f32 v248, v248, v130
    v_add_f32 v249, v249, v146
    v_add_f32 v248, v248, v131
    v_add_f32 v249, v249, v147
    v_add_f32 v248, v248, v132
    v_add_f32 v249, v249, v148
    v_add_f32 v248, v248, v133
    v_add_f32 v249, v249, v149
    v_add_f32 v248, v248, v134
    v_add_f32 v249, v249, v150
    v_add_f32 v248, v248, v135
    v_add_f32 v249, v249, v151
    v_add_f32 v248, v248, v136
    v_add_f32 v249, v249, v152
    v_add_f32 v248, v248, v137
    v_add_f32 v249, v249, v153
    v_add_f32 v248, v248, v138
    v_add_f32 v249, v249, v154
    v_add_f32 v248, v248, v139
    v_add_f32 v249, v249, v155
    v_add_f32 v250, v250, v143
    v_add_f32 v251, v251, v159
    v_fma_f32 v248, v250, v242, v248
    v_fma_f32 v249, v251, v242, v249
    v_mov_b32 v250, v248
    v_mov_b32 v251, v249
    s_nop 0
    v_permlane32_swap_b32 v248, v250
    v_permlane32_swap_b32 v249, v251
    v_add_f32 v248, v248, v250
    v_add_f32 v249, v249, v251
    v_rcp_f32 v248, v248
    v_rcp_f32 v249, v249
    v_mul_f32 v128, v128, v248
    v_mul_f32 v144, v144, v249
    v_mul_f32 v129, v129, v248
    v_mul_f32 v145, v145, v249
    v_mul_f32 v130, v130, v248
    v_mul_f32 v146, v146, v249
    v_mul_f32 v131, v131, v248
    v_mul_f32 v147, v147, v249
    v_mul_f32 v132, v132, v248
    v_mul_f32 v148, v148, v249
    v_mul_f32 v133, v133, v248
    v_mul_f32 v149, v149, v249
    v_mul_f32 v134, v134, v248
    v_mul_f32 v150, v150, v249
    v_mul_f32 v135, v135, v248
    v_mul_f32 v151, v151, v249
    v_mul_f32 v136, v136, v248
    v_mul_f32 v152, v152, v249
    v_mul_f32 v137, v137, v248
    v_mul_f32 v153, v153, v249
    v_mul_f32 v138, v138, v248
    v_mul_f32 v154, v154, v249
    v_mul_f32 v139, v139, v248
    v_mul_f32 v155, v155, v249
    v_mul_f32 v140, v140, v248
    v_mul_f32 v156, v156, v249
    v_mul_f32 v141, v141, v248
    v_mul_f32 v157, v157, v249
    v_mul_f32 v142, v142, v248
    v_mul_f32 v158, v158, v249
    v_mul_f32 v143, v143, v248
    v_mul_f32 v159, v159, v249
    v_cvt_pk_bf16_f32 v160, v128, v129
    v_cvt_pk_bf16_f32 v168, v144, v145
    v_cvt_pk_bf16_f32 v161, v130, v131
    v_cvt_pk_bf16_f32 v169, v146, v147
    v_cvt_pk_bf16_f32 v162, v132, v133
    v_cvt_pk_bf16_f32 v170, v148, v149
    v_cvt_pk_bf16_f32 v163, v134, v135
    v_cvt_pk_bf16_f32 v171, v150, v151
    v_cvt_pk_bf16_f32 v164, v136, v137
    v_cvt_pk_bf16_f32 v172, v152, v153
    v_cvt_pk_bf16_f32 v165, v138, v139
    v_cvt_pk_bf16_f32 v173, v154, v155
    v_cvt_pk_bf16_f32 v166, v140, v141
    v_cvt_pk_bf16_f32 v174, v156, v157
    v_cvt_pk_bf16_f32 v167, v142, v143
    v_cvt_pk_bf16_f32 v175, v158, v159
    ds_write_b128 v252, v[160:163] offset:0
    ds_write_b128 v252, v[164:167] offset:16
    ds_write_b128 v252, v[168:171] offset:2560
    ds_write_b128 v252, v[172:175] offset:2576
    s_add_u32 s64, s25, 0
    s_and_b32 s64, s64, 3
    s_lshl_b32 s64, s64, 14
    v_add_u32 v12, s64, v2
    ds_read_b128 v[16:19], v12 offset:14336
    ds_read_b128 v[20:23], v12 offset:15360
    s_add_u32 s64, s25, 1
    s_and_b32 s64, s64, 3
    s_lshl_b32 s64, s64, 14
    v_add_u32 v12, s64, v2
    ds_read_b128 v[24:27], v12 offset:14336
    ds_read_b128 v[28:31], v12 offset:15360
    s_add_u32 s64, s25, 2
    s_and_b32 s64, s64, 3
    s_lshl_b32 s64, s64, 14
    v_add_u32 v12, s64, v2
    ds_read_b128 v[32:35], v12 offset:14336
    ds_read_b128 v[36:39], v12 offset:15360
    s_add_u32 s64, s25, 3
    s_and_b32 s64, s64, 3
    s_lshl_b32 s64, s64, 14
    v_add_u32 v12, s64, v2
    ds_read_b128 v[40:43], v12 offset:14336
    ds_read_b128 v[44:47], v12 offset:15360
    s_lshl_b32 s64, s25, 8
    s_add_u32 s64, s64, 155648
    v_lshl_add_u32 v12, v0, 2, s64
    ds_read_b32 v241, v12
    s_mov_b64 exec, 1
    ds_add_u32 v5, v6 offset:12
    s_mov_b64 exec, -1
    s_cmp_lg_u32 s25, 0
    s_cbranch_scc1 L_g0_follow
    s_mov_b32 s61, 60000
L_g0_look:
    s_waitcnt vmcnt(0)
    v_cmp_ne_u32 vcc, s58, v244
    v_cmp_ne_u32 s[62:63], s58, v246
    v_max_f32 v245, v245, v247
    s_or_b64 vcc, vcc, s[62:63]
    s_cbranch_scc0 L_g0_kvok
    s_sub_u32 s61, s61, 1
    s_cbranch_scc1 L_g0_kvok
    s_sleep 4
    s_mov_b32 s60, 655488
    buffer_load_dwordx4 v[244:247], v254, s[16:19], s60 offen sc1
    s_branch L_g0_look
L_g0_kvok:
    v_or_b32 v245, 1, v245
    ds_max_u32 v5, v245 offset:56
    s_mov_b64 exec, 1
    ds_add_u32 v5, v6 offset:200
    s_mov_b64 exec, -1
L_g0_follow:
    s_mov_b32 s61, 300000
lw_22:
    ds_read_b32 v12, v5 offset:200
    s_waitcnt lgkmcnt(0)
    v_readfirstlane_b32 s60, v12
    s_sub_u32 s61, s61, 1
    s_cbranch_scc1 lwd_23
    s_cmp_ge_u32 s60, 1
    s_cbranch_scc1 lwd_23
    s_branch lw_22
lwd_23:
    ds_read_b32 v245, v5 offset:56
    s_add_u32 s64, s83, 0
    buffer_load_dwordx4 v[176:179], v2, s[16:19], s64 offen sc1
    buffer_load_dwordx4 v[180:183], v2, s[16:19], s64 offen offset:1024 sc1
    s_add_u32 s64, s83, 0
    buffer_load_dwordx4 v[208:211], v2, s[16:19], s64 offen offset:2048 sc1
    buffer_load_dwordx4 v[212:215], v2, s[16:19], s64 offen offset:3072 sc1
    s_mov_b64 exec, 1
    ds_add_u32 v5, v6 offset:0
    s_mov_b64 exec, -1
    s_add_u32 s64, s83, 4096
    buffer_load_dwordx4 v[184:187], v2, s[16:19], s64 offen sc1
    buffer_load_dwordx4 v[188:191], v2, s[16:19], s64 offen offset:1024 sc1
    s_add_u32 s64, s83, 4096
    buffer_load_dwordx4 v[216:219], v2, s[16:19], s64 offen offset:2048 sc1
    buffer_load_dwordx4 v[220:223], v2, s[16:19], s64 offen offset:3072 sc1
    s_add_u32 s64, s83, 8192
    buffer_load_dwordx4 v[192:195], v2, s[16:19], s64 offen sc1
    buffer_load_dwordx4 v[196:199], v2, s[16:19], s64 offen offset:1024 sc1
    v_mov_b32 v13, 0x42200000
    s_add_u32 s64, s83, 8192
    buffer_load_dwordx4 v[224:227], v2, s[16:19], s64 offen offset:2048 sc1
    buffer_load_dwordx4 v[228:231], v2, s[16:19], s64 offen offset:3072 sc1
    s_waitcnt lgkmcnt(0)
    s_mov_b32 exec_lo, 0
    v_fma_f32 v22, -v23, v245, v13
    v_fma_f32 v30, -v31, v245, v13
    v_fma_f32 v38, -v39, v245, v13
    v_fma_f32 v46, -v47, v245, v13
    v_cvt_pk_bf16_f32 v22, v22, 0
    v_cvt_pk_bf16_f32 v30, v30, 0
    v_cvt_pk_bf16_f32 v38, v38, 0
    v_cvt_pk_bf16_f32 v46, v46, 0
    v_mov_b32 v23, 0
    v_mov_b32 v31, 0
    v_mov_b32 v39, 0
    v_mov_b32 v47, 0
    s_mov_b32 exec_lo, -1
    s_add_u32 s64, s83, 12288
    buffer_load_dwordx4 v[200:203], v2, s[16:19], s64 offen sc1
    buffer_load_dwordx4 v[204:207], v2, s[16:19], s64 offen offset:1024 sc1
L_start:
    s_waitcnt vmcnt(10)
    v_mfma_f32_32x32x16_bf16 v[112:127], v[176:179], v[16:19], 0
    v_mfma_f32_32x32x16_bf16 v[112:127], v[180:183], v[20:23], v[112:127]
    s_add_u32 s64, s83, 61440
    buffer_load_dwordx4 v[244:247], v2, s[16:19], s64 offen offset:2048 sc1
    buffer_load_dwordx4 v[248:251], v2, s[16:19], s64 offen offset:3072 sc1
    v_mov_b32 v168, 0
    v_mov_b32 v169, 0
    v_mov_b32 v170, 0
    v_mov_b32 v171, 0
    v_mov_b32 v172, 0
    v_mov_b32 v173, 0
    v_mov_b32 v174, 0
    v_mov_b32 v175, 0
    s_add_u32 s64, s83, 14336
    s_add_u32 s66, s56, s64
    s_addc_u32 s67, s57, 0
    s_mov_b32 s68, 3
.p2align 6
L_loop:
    v_mfma_f32_32x32x16_bf16 v[128:143], v[176:179], v[24:27], 0
    v_exp_f32 v112, v112
    v_exp_f32 v113, v113
    v_exp_f32 v114, v114
    v_exp_f32 v115, v115
    v_mfma_f32_32x32x16_bf16 v[128:143], v[180:183], v[28:31], v[128:143]
    v_exp_f32 v116, v116
    v_exp_f32 v117, v117
    v_exp_f32 v118, v118
    v_exp_f32 v119, v119
    v_smfmac_f32_32x32x32_bf16 v[96:111], v[236:239], v[168:175], v240
    global_load_dwordx4 v[232:235], v2, s[66:67] offset:0 sc1
    v_exp_f32 v120, v120
    v_exp_f32 v121, v121
    v_exp_f32 v122, v122
    v_exp_f32 v123, v123
    v_smfmac_f32_32x32x32_bf16 v[48:63], v[208:211], v[112:119], v240
    global_load_dwordx4 v[236:239], v2, s[66:67] offset:1024 sc1
    v_exp_f32 v124, v124
    v_exp_f32 v125, v125
    v_exp_f32 v126, v126
    v_exp_f32 v127, v127
    v_mfma_f32_32x32x16_bf16 v[144:159], v[176:179], v[32:35], 0
    v_exp_f32 v128, v128
    v_exp_f32 v129, v129
    v_exp_f32 v130, v130
    v_exp_f32 v131, v131
    v_mfma_f32_32x32x16_bf16 v[144:159], v[180:183], v[36:39], v[144:159]
    v_exp_f32 v132, v132
    v_exp_f32 v133, v133
    v_exp_f32 v134, v134
    v_exp_f32 v135, v135
    v_smfmac_f32_32x32x32_bf16 v[48:63], v[212:215], v[120:127], v240
    v_exp_f32 v136, v136
    v_exp_f32 v137, v137
    v_exp_f32 v138, v138
    v_exp_f32 v139, v139
    v_smfmac_f32_32x32x32_bf16 v[64:79], v[208:211], v[128:135], v240
    v_exp_f32 v140, v140
    v_exp_f32 v141, v141
    v_exp_f32 v142, v142
    v_exp_f32 v143, v143
    v_mfma_f32_32x32x16_bf16 v[160:175], v[176:179], v[40:43], 0
    v_exp_f32 v144, v144
    v_exp_f32 v145, v145
    v_exp_f32 v146, v146
    v_exp_f32 v147, v147
    v_mfma_f32_32x32x16_bf16 v[160:175], v[180:183], v[44:47], v[160:175]
    s_waitcnt vmcnt(8)
    v_exp_f32 v148, v148
    v_exp_f32 v149, v149
    v_exp_f32 v150, v150
    v_exp_f32 v151, v151
    v_smfmac_f32_32x32x32_bf16 v[64:79], v[212:215], v[136:143], v240
    global_load_dwordx4 v[176:179], v2, s[66:67] offset:2048 sc1
    v_exp_f32 v152, v152
    v_exp_f32 v153, v153
    v_exp_f32 v154, v154
    v_exp_f32 v155, v155
    v_smfmac_f32_32x32x32_bf16 v[80:95], v[208:211], v[144:151], v240
    global_load_dwordx4 v[180:183], v2, s[66:67] offset:3072 sc1
    v_exp_f32 v156, v156
    v_exp_f32 v157, v157
    v_exp_f32 v158, v158
    v_exp_f32 v159, v159
    v_mfma_f32_32x32x16_bf16 v[112:127], v[184:187], v[16:19], 0
    s_add_u32 s66, s66, 0x1000
    v_exp_f32 v160, v160
    v_exp_f32 v161, v161
    v_exp_f32 v162, v162
    v_exp_f32 v163, v163
    v_mfma_f32_32x32x16_bf16 v[112:127], v[188:191], v[20:23], v[112:127]
    s_addc_u32 s67, s67, 0
    v_exp_f32 v164, v164
    v_exp_f32 v165, v165
    v_exp_f32 v166, v166
    v_exp_f32 v167, v167
    v_smfmac_f32_32x32x32_bf16 v[80:95], v[212:215], v[152:159], v240
    v_exp_f32 v168, v168
    v_exp_f32 v169, v169
    v_exp_f32 v170, v170
    v_exp_f32 v171, v171
    v_smfmac_f32_32x32x32_bf16 v[96:111], v[208:211], v[160:167], v240
    v_exp_f32 v172, v172
    v_exp_f32 v173, v173
    v_exp_f32 v174, v174
    v_exp_f32 v175, v175
    v_mfma_f32_32x32x16_bf16 v[128:143], v[184:187], v[24:27], 0
    v_exp_f32 v112, v112
    v_exp_f32 v113, v113
    v_exp_f32 v114, v114
    v_exp_f32 v115, v115
    v_mfma_f32_32x32x16_bf16 v[128:143], v[188:191], v[28:31], v[128:143]
    v_exp_f32 v116, v116
    v_exp_f32 v117, v117
    v_exp_f32 v118, v118
    v_exp_f32 v119, v119
    v_smfmac_f32_32x32x32_bf16 v[96:111], v[212:215], v[168:175], v240
    global_load_dwordx4 v[208:211], v2, s[66:67] offset:0 sc1
    v_exp_f32 v120, v120
    v_exp_f32 v121, v121
    v_exp_f32 v122, v122
    v_exp_f32 v123, v123
    v_smfmac_f32_32x32x32_bf16 v[48:63], v[216:219], v[112:119], v240
    global_load_dwordx4 v[212:215], v2, s[66:67] offset:1024 sc1
    v_exp_f32 v124, v124
    v_exp_f32 v125, v125
    v_exp_f32 v126, v126
    v_exp_f32 v127, v127
    v_mfma_f32_32x32x16_bf16 v[144:159], v[184:187], v[32:35], 0
    v_exp_f32 v128, v128
    v_exp_f32 v129, v129
    v_exp_f32 v130, v130
    v_exp_f32 v131, v131
    v_mfma_f32_32x32x16_bf16 v[144:159], v[188:191], v[36:39], v[144:159]
    v_exp_f32 v132, v132
    v_exp_f32 v133, v133
    v_exp_f32 v134, v134
    v_exp_f32 v135, v135
    v_smfmac_f32_32x32x32_bf16 v[48:63], v[220:223], v[120:127], v240
    v_exp_f32 v136, v136
    v_exp_f32 v137, v137
    v_exp_f32 v138, v138
    v_exp_f32 v139, v139
    v_smfmac_f32_32x32x32_bf16 v[64:79], v[216:219], v[128:135], v240
    v_exp_f32 v140, v140
    v_exp_f32 v141, v141
    v_exp_f32 v142, v142
    v_exp_f32 v143, v143
    v_mfma_f32_32x32x16_bf16 v[160:175], v[184:187], v[40:43], 0
    v_exp_f32 v144, v144
    v_exp_f32 v145, v145
    v_exp_f32 v146, v146
    v_exp_f32 v147, v147
    v_mfma_f32_32x32x16_bf16 v[160:175], v[188:191], v[44:47], v[160:175]
    s_waitcnt vmcnt(8)
    v_exp_f32 v148, v148
    v_exp_f32 v149, v149
    v_exp_f32 v150, v150
    v_exp_f32 v151, v151
    v_smfmac_f32_32x32x32_bf16 v[64:79], v[220:223], v[136:143], v240
    global_load_dwordx4 v[184:187], v2, s[66:67] offset:2048 sc1
    v_exp_f32 v152, v152
    v_exp_f32 v153, v153
    v_exp_f32 v154, v154
    v_exp_f32 v155, v155
    v_smfmac_f32_32x32x32_bf16 v[80:95], v[216:219], v[144:151], v240
    global_load_dwordx4 v[188:191], v2, s[66:67] offset:3072 sc1
    v_exp_f32 v156, v156
    v_exp_f32 v157, v157
    v_exp_f32 v158, v158
    v_exp_f32 v159, v159
    v_mfma_f32_32x32x16_bf16 v[112:127], v[192:195], v[16:19], 0
    s_add_u32 s66, s66, 0x1000
    v_exp_f32 v160, v160
    v_exp_f32 v161, v161
    v_exp_f32 v162, v162
    v_exp_f32 v163, v163
    v_mfma_f32_32x32x16_bf16 v[112:127], v[196:199], v[20:23], v[112:127]
    s_addc_u32 s67, s67, 0
    v_exp_f32 v164, v164
    v_exp_f32 v165, v165
    v_exp_f32 v166, v166
    v_exp_f32 v167, v167
    v_smfmac_f32_32x32x32_bf16 v[80:95], v[220:223], v[152:159], v240
    v_exp_f32 v168, v168
    v_exp_f32 v169, v169
    v_exp_f32 v170, v170
    v_exp_f32 v171, v171
    v_smfmac_f32_32x32x32_bf16 v[96:111], v[216:219], v[160:167], v240
    v_exp_f32 v172, v172
    v_exp_f32 v173, v173
    v_exp_f32 v174, v174
    v_exp_f32 v175, v175
    v_mfma_f32_32x32x16_bf16 v[128:143], v[192:195], v[24:27], 0
    v_exp_f32 v112, v112
    v_exp_f32 v113, v113
    v_exp_f32 v114, v114
    v_exp_f32 v115, v115
    v_mfma_f32_32x32x16_bf16 v[128:143], v[196:199], v[28:31], v[128:143]
    v_exp_f32 v116, v116
    v_exp_f32 v117, v117
    v_exp_f32 v118, v118
    v_exp_f32 v119, v119
    v_smfmac_f32_32x32x32_bf16 v[96:111], v[220:223], v[168:175], v240
    global_load_dwordx4 v[216:219], v2, s[66:67] offset:0 sc1
    v_exp_f32 v120, v120
    v_exp_f32 v121, v121
    v_exp_f32 v122, v122
    v_exp_f32 v123, v123
    v_smfmac_f32_32x32x32_bf16 v[48:63], v[224:227], v[112:119], v240
    global_load_dwordx4 v[220:223], v2, s[66:67] offset:1024 sc1
    v_exp_f32 v124, v124
    v_exp_f32 v125, v125
    v_exp_f32 v126, v126
    v_exp_f32 v127, v127
    v_mfma_f32_32x32x16_bf16 v[144:159], v[192:195], v[32:35], 0
    v_exp_f32 v128, v128
    v_exp_f32 v129, v129
    v_exp_f32 v130, v130
    v_exp_f32 v131, v131
    v_mfma_f32_32x32x16_bf16 v[144:159], v[196:199], v[36:39], v[144:159]
    v_exp_f32 v132, v132
    v_exp_f32 v133, v133
    v_exp_f32 v134, v134
    v_exp_f32 v135, v135
    v_smfmac_f32_32x32x32_bf16 v[48:63], v[228:231], v[120:127], v240
    v_exp_f32 v136, v136
    v_exp_f32 v137, v137
    v_exp_f32 v138, v138
    v_exp_f32 v139, v139
    v_smfmac_f32_32x32x32_bf16 v[64:79], v[224:227], v[128:135], v240
    v_exp_f32 v140, v140
    v_exp_f32 v141, v141
    v_exp_f32 v142, v142
    v_exp_f32 v143, v143
    v_mfma_f32_32x32x16_bf16 v[160:175], v[192:195], v[40:43], 0
    v_exp_f32 v144, v144
    v_exp_f32 v145, v145
    v_exp_f32 v146, v146
    v_exp_f32 v147, v147
    v_mfma_f32_32x32x16_bf16 v[160:175], v[196:199], v[44:47], v[160:175]
    s_waitcnt vmcnt(8)
    v_exp_f32 v148, v148
    v_exp_f32 v149, v149
    v_exp_f32 v150, v150
    v_exp_f32 v151, v151
    v_smfmac_f32_32x32x32_bf16 v[64:79], v[228:231], v[136:143], v240
    global_load_dwordx4 v[192:195], v2, s[66:67] offset:2048 sc1
    v_exp_f32 v152, v152
    v_exp_f32 v153, v153
    v_exp_f32 v154, v154
    v_exp_f32 v155, v155
    v_smfmac_f32_32x32x32_bf16 v[80:95], v[224:227], v[144:151], v240
    global_load_dwordx4 v[196:199], v2, s[66:67] offset:3072 sc1
    v_exp_f32 v156, v156
    v_exp_f32 v157, v157
    v_exp_f32 v158, v158
    v_exp_f32 v159, v159
    v_mfma_f32_32x32x16_bf16 v[112:127], v[200:203], v[16:19], 0
    s_add_u32 s66, s66, 0x1000
    v_exp_f32 v160, v160
    v_exp_f32 v161, v161
    v_exp_f32 v162, v162
    v_exp_f32 v163, v163
    v_mfma_f32_32x32x16_bf16 v[112:127], v[204:207], v[20:23], v[112:127]
    s_addc_u32 s67, s67, 0
    v_exp_f32 v164, v164
    v_exp_f32 v165, v165
    v_exp_f32 v166, v166
    v_exp_f32 v167, v167
    v_smfmac_f32_32x32x32_bf16 v[80:95], v[228:231], v[152:159], v240
    v_exp_f32 v168, v168
    v_exp_f32 v169, v169
    v_exp_f32 v170, v170
    v_exp_f32 v171, v171
    v_smfmac_f32_32x32x32_bf16 v[96:111], v[224:227], v[160:167], v240
    v_exp_f32 v172, v172
    v_exp_f32 v173, v173
    v_exp_f32 v174, v174
    v_exp_f32 v175, v175
    v_mfma_f32_32x32x16_bf16 v[128:143], v[200:203], v[24:27], 0
    v_exp_f32 v112, v112
    v_exp_f32 v113, v113
    v_exp_f32 v114, v114
    v_exp_f32 v115, v115
    v_mfma_f32_32x32x16_bf16 v[128:143], v[204:207], v[28:31], v[128:143]
    v_exp_f32 v116, v116
    v_exp_f32 v117, v117
    v_exp_f32 v118, v118
    v_exp_f32 v119, v119
    v_smfmac_f32_32x32x32_bf16 v[96:111], v[228:231], v[168:175], v240
    global_load_dwordx4 v[224:227], v2, s[66:67] offset:0 sc1
    v_exp_f32 v120, v120
    v_exp_f32 v121, v121
    v_exp_f32 v122, v122
    v_exp_f32 v123, v123
    v_smfmac_f32_32x32x32_bf16 v[48:63], v[232:235], v[112:119], v240
    global_load_dwordx4 v[228:231], v2, s[66:67] offset:1024 sc1
    v_exp_f32 v124, v124
    v_exp_f32 v125, v125
    v_exp_f32 v126, v126
    v_exp_f32 v127, v127
    v_mfma_f32_32x32x16_bf16 v[144:159], v[200:203], v[32:35], 0
    v_exp_f32 v128, v128
    v_exp_f32 v129, v129
    v_exp_f32 v130, v130
    v_exp_f32 v131, v131
    v_mfma_f32_32x32x16_bf16 v[144:159], v[204:207], v[36:39], v[144:159]
    v_exp_f32 v132, v132
    v_exp_f32 v133, v133
    v_exp_f32 v134, v134
    v_exp_f32 v135, v135
    v_smfmac_f32_32x32x32_bf16 v[48:63], v[236:239], v[120:127], v240
    v_exp_f32 v136, v136
    v_exp_f32 v137, v137
    v_exp_f32 v138, v138
    v_exp_f32 v139, v139
    v_smfmac_f32_32x32x32_bf16 v[64:79], v[232:235], v[128:135], v240
    v_exp_f32 v140, v140
    v_exp_f32 v141, v141
    v_exp_f32 v142, v142
    v_exp_f32 v143, v143
    v_mfma_f32_32x32x16_bf16 v[160:175], v[200:203], v[40:43], 0
    v_exp_f32 v144, v144
    v_exp_f32 v145, v145
    v_exp_f32 v146, v146
    v_exp_f32 v147, v147
    v_mfma_f32_32x32x16_bf16 v[160:175], v[204:207], v[44:47], v[160:175]
    s_waitcnt vmcnt(8)
    v_exp_f32 v148, v148
    v_exp_f32 v149, v149
    v_exp_f32 v150, v150
    v_exp_f32 v151, v151
    v_smfmac_f32_32x32x32_bf16 v[64:79], v[236:239], v[136:143], v240
    global_load_dwordx4 v[200:203], v2, s[66:67] offset:2048 sc1
    v_exp_f32 v152, v152
    v_exp_f32 v153, v153
    v_exp_f32 v154, v154
    v_exp_f32 v155, v155
    v_smfmac_f32_32x32x32_bf16 v[80:95], v[232:235], v[144:151], v240
    global_load_dwordx4 v[204:207], v2, s[66:67] offset:3072 sc1
    v_exp_f32 v156, v156
    v_exp_f32 v157, v157
    v_exp_f32 v158, v158
    v_exp_f32 v159, v159
    v_mfma_f32_32x32x16_bf16 v[112:127], v[176:179], v[16:19], 0
    s_add_u32 s66, s66, 0x1000
    v_exp_f32 v160, v160
    v_exp_f32 v161, v161
    v_exp_f32 v162, v162
    v_exp_f32 v163, v163
    v_mfma_f32_32x32x16_bf16 v[112:127], v[180:183], v[20:23], v[112:127]
    s_addc_u32 s67, s67, 0
    v_exp_f32 v164, v164
    v_exp_f32 v165, v165
    v_exp_f32 v166, v166
    v_exp_f32 v167, v167
    v_smfmac_f32_32x32x32_bf16 v[80:95], v[236:239], v[152:159], v240
    s_sub_u32 s68, s68, 1
    v_exp_f32 v168, v168
    v_exp_f32 v169, v169
    v_exp_f32 v170, v170
    v_exp_f32 v171, v171
    v_smfmac_f32_32x32x32_bf16 v[96:111], v[232:235], v[160:167], v240
    s_cmp_lg_u32 s68, 0
    v_exp_f32 v172, v172
    v_exp_f32 v173, v173
    v_exp_f32 v174, v174
    v_exp_f32 v175, v175
    s_cbranch_scc1 L_loop
    v_mfma_f32_32x32x16_bf16 v[128:143], v[176:179], v[24:27], 0
    v_exp_f32 v112, v112
    v_exp_f32 v113, v113
    v_exp_f32 v114, v114
    v_exp_f32 v115, v115
    v_mfma_f32_32x32x16_bf16 v[128:143], v[180:183], v[28:31], v[128:143]
    v_exp_f32 v116, v116
    v_exp_f32 v117, v117
    v_exp_f32 v118, v118
    v_exp_f32 v119, v119
    v_smfmac_f32_32x32x32_bf16 v[96:111], v[236:239], v[168:175], v240
    v_exp_f32 v120, v120
    v_exp_f32 v121, v121
    v_exp_f32 v122, v122
    v_exp_f32 v123, v123
    v_smfmac_f32_32x32x32_bf16 v[48:63], v[208:211], v[112:119], v240
    v_exp_f32 v124, v124
    v_exp_f32 v125, v125
    v_exp_f32 v126, v126
    v_exp_f32 v127, v127
    v_mfma_f32_32x32x16_bf16 v[144:159], v[176:179], v[32:35], 0
    v_exp_f32 v128, v128
    v_exp_f32 v129, v129
    v_exp_f32 v130, v130
    v_exp_f32 v131, v131
    v_mfma_f32_32x32x16_bf16 v[144:159], v[180:183], v[36:39], v[144:159]
    v_exp_f32 v132, v132
    v_exp_f32 v133, v133
    v_exp_f32 v134, v134
    v_exp_f32 v135, v135
    v_smfmac_f32_32x32x32_bf16 v[48:63], v[212:215], v[120:127], v240
    v_exp_f32 v136, v136
    v_exp_f32 v137, v137
    v_exp_f32 v138, v138
    v_exp_f32 v139, v139
    v_smfmac_f32_32x32x32_bf16 v[64:79], v[208:211], v[128:135], v240
    v_exp_f32 v140, v140
    v_exp_f32 v141, v141
    v_exp_f32 v142, v142
    v_exp_f32 v143, v143
    v_mfma_f32_32x32x16_bf16 v[160:175], v[176:179], v[40:43], 0
    v_exp_f32 v144, v144
    v_exp_f32 v145, v145
    v_exp_f32 v146, v146
    v_exp_f32 v147, v147
    v_mfma_f32_32x32x16_bf16 v[160:175], v[180:183], v[44:47], v[160:175]
    v_exp_f32 v148, v148
    v_exp_f32 v149, v149
    v_exp_f32 v150, v150
    v_exp_f32 v151, v151
    v_smfmac_f32_32x32x32_bf16 v[64:79], v[212:215], v[136:143], v240
    v_exp_f32 v152, v152
    v_exp_f32 v153, v153
    v_exp_f32 v154, v154
    v_exp_f32 v155, v155
    v_smfmac_f32_32x32x32_bf16 v[80:95], v[208:211], v[144:151], v240
    s_waitcnt vmcnt(6)
    v_exp_f32 v156, v156
    v_exp_f32 v157, v157
    v_exp_f32 v158, v158
    v_exp_f32 v159, v159
    v_mfma_f32_32x32x16_bf16 v[112:127], v[184:187], v[24:27], 0
    v_exp_f32 v160, v160
    v_exp_f32 v161, v161
    v_exp_f32 v162, v162
    v_exp_f32 v163, v163
    v_mfma_f32_32x32x16_bf16 v[112:127], v[188:191], v[28:31], v[112:127]
    v_exp_f32 v164, v164
    v_exp_f32 v165, v165
    v_exp_f32 v166, v166
    v_exp_f32 v167, v167
    v_smfmac_f32_32x32x32_bf16 v[80:95], v[212:215], v[152:159], v240
    v_exp_f32 v168, v168
    v_exp_f32 v169, v169
    v_exp_f32 v170, v170
    v_exp_f32 v171, v171
    v_smfmac_f32_32x32x32_bf16 v[96:111], v[208:211], v[160:167], v240
    s_waitcnt vmcnt(2)
    v_exp_f32 v172, v172
    v_exp_f32 v173, v173
    v_exp_f32 v174, v174
    v_exp_f32 v175, v175
    v_mfma_f32_32x32x16_bf16 v[128:143], v[192:195], v[24:27], 0
    v_exp_f32 v112, v112
    v_exp_f32 v113, v113
    v_exp_f32 v114, v114
    v_exp_f32 v115, v115
    v_mfma_f32_32x32x16_bf16 v[128:143], v[196:199], v[28:31], v[128:143]
    v_exp_f32 v116, v116
    v_exp_f32 v117, v117
    v_exp_f32 v118, v118
    v_exp_f32 v119, v119
    v_smfmac_f32_32x32x32_bf16 v[96:111], v[212:215], v[168:175], v240
    v_exp_f32 v120, v120
    v_exp_f32 v121, v121
    v_exp_f32 v122, v122
    v_exp_f32 v123, v123
    v_smfmac_f32_32x32x32_bf16 v[64:79], v[216:219], v[112:119], v240
    s_waitcnt vmcnt(0)
    v_exp_f32 v124, v124
    v_exp_f32 v125, v125
    v_exp_f32 v126, v126
    v_exp_f32 v127, v127
    v_mfma_f32_32x32x16_bf16 v[144:159], v[200:203], v[24:27], 0
    v_exp_f32 v128, v128
    v_exp_f32 v129, v129
    v_exp_f32 v130, v130
    v_exp_f32 v131, v131
    v_mfma_f32_32x32x16_bf16 v[144:159], v[204:207], v[28:31], v[144:159]
    v_exp_f32 v132, v132
    v_exp_f32 v133, v133
    v_exp_f32 v134, v134
    v_exp_f32 v135, v135
    v_smfmac_f32_32x32x32_bf16 v[64:79], v[220:223], v[120:127], v240
    v_exp_f32 v136, v136
    v_exp_f32 v137, v137
    v_exp_f32 v138, v138
    v_exp_f32 v139, v139
    v_smfmac_f32_32x32x32_bf16 v[64:79], v[224:227], v[128:135], v240
    v_exp_f32 v140, v140
    v_exp_f32 v141, v141
    v_exp_f32 v142, v142
    v_exp_f32 v143, v143
    v_mfma_f32_32x32x16_bf16 v[160:175], v[184:187], v[32:35], 0
    v_exp_f32 v144, v144
    v_exp_f32 v145, v145
    v_exp_f32 v146, v146
    v_exp_f32 v147, v147
    v_mfma_f32_32x32x16_bf16 v[160:175], v[188:191], v[36:39], v[160:175]
    v_exp_f32 v148, v148
    v_exp_f32 v149, v149
    v_exp_f32 v150, v150
    v_exp_f32 v151, v151
    v_smfmac_f32_32x32x32_bf16 v[64:79], v[228:231], v[136:143], v240
    ds_read_b32 v12, v5 offset:24
    v_exp_f32 v152, v152
    v_exp_f32 v153, v153
    v_exp_f32 v154, v154
    v_exp_f32 v155, v155
    v_smfmac_f32_32x32x32_bf16 v[64:79], v[244:247], v[144:151], v240
    v_exp_f32 v156, v156
    v_exp_f32 v157, v157
    v_exp_f32 v158, v158
    v_exp_f32 v159, v159
    v_mfma_f32_32x32x16_bf16 v[112:127], v[192:195], v[32:35], 0
    s_waitcnt lgkmcnt(0)
    v_readfirstlane_b32 s60, v12
    v_exp_f32 v160, v160
    v_exp_f32 v161, v161
    v_exp_f32 v162, v162
    v_exp_f32 v163, v163
    v_mfma_f32_32x32x16_bf16 v[112:127], v[196:199], v[36:39], v[112:127]
    v_exp_f32 v164, v164
    v_exp_f32 v165, v165
    v_exp_f32 v166, v166
    v_exp_f32 v167, v167
    v_smfmac_f32_32x32x32_bf16 v[64:79], v[248:251], v[152:159], v240
    s_cmp_ge_u32 s60, 8
    s_cbranch_scc0 L_wslow
L_wok:
    v_exp_f32 v168, v168
    v_exp_f32 v169, v169
    v_exp_f32 v170, v170
    v_exp_f32 v171, v171
    v_smfmac_f32_32x32x32_bf16 v[80:95], v[216:219], v[160:167], v240
    v_exp_f32 v172, v172
    v_exp_f32 v173, v173
    v_exp_f32 v174, v174
    v_exp_f32 v175, v175
    v_mfma_f32_32x32x16_bf16 v[128:143], v[200:203], v[32:35], 0
    v_exp_f32 v112, v112
    v_exp_f32 v113, v113
    v_exp_f32 v114, v114
    v_exp_f32 v115, v115
    v_mfma_f32_32x32x16_bf16 v[128:143], v[204:207], v[36:39], v[128:143]
    v_exp_f32 v116, v116
    v_exp_f32 v117, v117
    v_exp_f32 v118, v118
    v_exp_f32 v119, v119
    v_smfmac_f32_32x32x32_bf16 v[80:95], v[220:223], v[168:175], v240
    ds_write_b128 v8, v[64:67] offset:0
    v_exp_f32 v120, v120
    v_exp_f32 v121, v121
    v_exp_f32 v122, v122
    v_exp_f32 v123, v123
    v_smfmac_f32_32x32x32_bf16 v[80:95], v[224:227], v[112:119], v240
    ds_write_b128 v8, v[68:71] offset:1024
    v_exp_f32 v124, v124
    v_exp_f32 v125, v125
    v_exp_f32 v126, v126
    v_exp_f32 v127, v127
    v_mfma_f32_32x32x16_bf16 v[144:159], v[184:187], v[40:43], 0
    v_exp_f32 v128, v128
    v_exp_f32 v129, v129
    v_exp_f32 v130, v130
    v_exp_f32 v131, v131
    v_mfma_f32_32x32x16_bf16 v[144:159], v[188:191], v[44:47], v[144:159]
    v_exp_f32 v132, v132
    v_exp_f32 v133, v133
    v_exp_f32 v134, v134
    v_exp_f32 v135, v135
    v_smfmac_f32_32x32x32_bf16 v[80:95], v[228:231], v[120:127], v240
    ds_write_b128 v8, v[72:75] offset:2048
    v_exp_f32 v136, v136
    v_exp_f32 v137, v137
    v_exp_f32 v138, v138
    v_exp_f32 v139, v139
    v_smfmac_f32_32x32x32_bf16 v[80:95], v[244:247], v[128:135], v240
    ds_write_b128 v8, v[76:79] offset:3072
    v_exp_f32 v140, v140
    v_exp_f32 v141, v141
    v_exp_f32 v142, v142
    v_exp_f32 v143, v143
    v_mfma_f32_32x32x16_bf16 v[160:175], v[192:195], v[40:43], 0
    s_mov_b64 exec, 1
    buffer_store_dword v255, v2, s[16:19], s74 offen sc1
    s_mov_b64 exec, -1
    v_exp_f32 v144, v144
    v_exp_f32 v145, v145
    v_exp_f32 v146, v146
    v_exp_f32 v147, v147
    v_mfma_f32_32x32x16_bf16 v[160:175], v[196:199], v[44:47], v[160:175]
    v_exp_f32 v148, v148
    v_exp_f32 v149, v149
    v_exp_f32 v150, v150
    v_exp_f32 v151, v151
    v_smfmac_f32_32x32x32_bf16 v[80:95], v[248:251], v[136:143], v240
    v_exp_f32 v152, v152
    v_exp_f32 v153, v153
    v_exp_f32 v154, v154
    v_exp_f32 v155, v155
    v_smfmac_f32_32x32x32_bf16 v[96:111], v[216:219], v[144:151], v240
    v_exp_f32 v156, v156
    v_exp_f32 v157, v157
    v_exp_f32 v158, v158
    v_exp_f32 v159, v159
    v_mfma_f32_32x32x16_bf16 v[112:127], v[200:203], v[40:43], 0
    v_exp_f32 v160, v160
    v_exp_f32 v161, v161
    v_exp_f32 v162, v162
    v_exp_f32 v163, v163
    v_mfma_f32_32x32x16_bf16 v[112:127], v[204:207], v[44:47], v[112:127]
    v_exp_f32 v164, v164
    v_exp_f32 v165, v165
    v_exp_f32 v166, v166
    v_exp_f32 v167, v167
    v_smfmac_f32_32x32x32_bf16 v[96:111], v[220:223], v[152:159], v240
    ds_write_b128 v9, v[80:83] offset:0
    v_exp_f32 v168, v168
    v_exp_f32 v169, v169
    v_exp_f32 v170, v170
    v_exp_f32 v171, v171
    v_smfmac_f32_32x32x32_bf16 v[96:111], v[224:227], v[160:167], v240
    ds_write_b128 v9, v[84:87] offset:1024
    v_exp_f32 v172, v172
    v_exp_f32 v173, v173
    v_exp_f32 v174, v174
    v_exp_f32 v175, v175
    v_mfma_f32_32x32x16_bf16 v[128:143], v[184:187], v[16:19], 0
    v_exp_f32 v112, v112
    v_exp_f32 v113, v113
    v_exp_f32 v114, v114
    v_exp_f32 v115, v115
    v_mfma_f32_32x32x16_bf16 v[128:143], v[188:191], v[20:23], v[128:143]
    v_exp_f32 v116, v116
    v_exp_f32 v117, v117
    v_exp_f32 v118, v118
    v_exp_f32 v119, v119
    v_smfmac_f32_32x32x32_bf16 v[96:111], v[228:231], v[168:175], v240
    ds_write_b128 v9, v[88:91] offset:2048
    v_exp_f32 v120, v120
    v_exp_f32 v121, v121
    v_exp_f32 v122, v122
    v_exp_f32 v123, v123
    v_smfmac_f32_32x32x32_bf16 v[96:111], v[244:247], v[112:119], v240
    ds_write_b128 v9, v[92:95] offset:3072
    v_exp_f32 v124, v124
    v_exp_f32 v125, v125
    v_exp_f32 v126, v126
    v_exp_f32 v127, v127
    v_mfma_f32_32x32x16_bf16 v[144:159], v[192:195], v[16:19], 0
    v_exp_f32 v128, v128
    v_exp_f32 v129, v129
    v_exp_f32 v130, v130
    v_exp_f32 v131, v131
    v_mfma_f32_32x32x16_bf16 v[144:159], v[196:199], v[20:23], v[144:159]
    v_exp_f32 v132, v132
    v_exp_f32 v133, v133
    v_exp_f32 v134, v134
    v_exp_f32 v135, v135
    v_smfmac_f32_32x32x32_bf16 v[96:111], v[248:251], v[120:127], v240
    v_exp_f32 v136, v136
    v_exp_f32 v137, v137
    v_exp_f32 v138, v138
    v_exp_f32 v139, v139
    v_smfmac_f32_32x32x32_bf16 v[48:63], v[216:219], v[128:135], v240
    v_exp_f32 v140, v140
    v_exp_f32 v141, v141
    v_exp_f32 v142, v142
    v_exp_f32 v143, v143
    v_mfma_f32_32x32x16_bf16 v[160:175], v[200:203], v[16:19], 0
    v_exp_f32 v144, v144
    v_exp_f32 v145, v145
    v_exp_f32 v146, v146
    v_exp_f32 v147, v147
    v_mfma_f32_32x32x16_bf16 v[160:175], v[204:207], v[20:23], v[160:175]
    ds_write_b128 v10, v[96:99] offset:0
    v_exp_f32 v148, v148
    v_exp_f32 v149, v149
    v_exp_f32 v150, v150
    v_exp_f32 v151, v151
    v_smfmac_f32_32x32x32_bf16 v[48:63], v[220:223], v[136:143], v240
    ds_write_b128 v10, v[100:103] offset:1024
    v_exp_f32 v152, v152
    v_exp_f32 v153, v153
    v_exp_f32 v154, v154
    v_exp_f32 v155, v155
    v_smfmac_f32_32x32x32_bf16 v[48:63], v[224:227], v[144:151], v240
    ds_write_b128 v10, v[104:107] offset:2048
    v_exp_f32 v156, v156
    v_exp_f32 v157, v157
    v_exp_f32 v158, v158
    v_exp_f32 v159, v159
    ds_write_b128 v10, v[108:111] offset:3072
    s_mov_b64 exec, 1
    ds_add_u32 v5, v6 offset:16
    s_mov_b64 exec, -1
    v_exp_f32 v160, v160
    v_exp_f32 v161, v161
    v_exp_f32 v162, v162
    v_exp_f32 v163, v163
    v_exp_f32 v164, v164
    v_exp_f32 v165, v165
    v_exp_f32 v166, v166
    v_exp_f32 v167, v167
    v_smfmac_f32_32x32x32_bf16 v[48:63], v[228:231], v[152:159], v240
    v_exp_f32 v168, v168
    v_exp_f32 v169, v169
    v_exp_f32 v170, v170
    v_exp_f32 v171, v171
    v_smfmac_f32_32x32x32_bf16 v[48:63], v[244:247], v[160:167], v240
    ds_read_b32 v12, v5 offset:16
    v_exp_f32 v172, v172
    v_exp_f32 v173, v173
    v_exp_f32 v174, v174
    v_exp_f32 v175, v175
    s_nop 1
    v_smfmac_f32_32x32x32_bf16 v[48:63], v[248:251], v[168:175], v240
    s_waitcnt lgkmcnt(0)
    v_readfirstlane_b32 s60, v12
    s_nop 0
    s_cmp_ge_u32 s60, s78
    s_cbranch_scc1 L_ook
    s_mov_b32 s61, 300000
lw_24:
    ds_read_b32 v12, v5 offset:16
    s_waitcnt lgkmcnt(0)
    v_readfirstlane_b32 s60, v12
    s_sub_u32 s61, s61, 1
    s_cbranch_scc1 lwd_25
    s_cmp_ge_u32 s60, s78
    s_cbranch_scc1 lwd_25
    s_branch lw_24
lwd_25:
L_ook:
    ds_read_b128 v[68:71], v11 offset:1024
    ds_read_b128 v[84:87], v11 offset:5120
    ds_read_b128 v[100:103], v11 offset:9216
    ds_read_b128 v[64:67], v11 offset:0
    ds_read_b128 v[80:83], v11 offset:4096
    ds_read_b128 v[96:99], v11 offset:8192
    ds_read_b128 v[72:75], v11 offset:2048
    ds_read_b128 v[88:91], v11 offset:6144
    ds_read_b128 v[104:107], v11 offset:10240
    ds_read_b128 v[76:79], v11 offset:3072
    ds_read_b128 v[92:95], v11 offset:7168
    ds_read_b128 v[108:111], v11 offset:11264
    s_mov_b32 s72, 0x5d800000
    v_sub_f32 v112, 1.0, v241
    s_waitcnt lgkmcnt(9)
    v_pk_add_f32 v[70:71], v[70:71], v[86:87]
    v_pk_add_f32 v[68:69], v[68:69], v[84:85]
    v_pk_add_f32 v[54:55], v[54:55], v[102:103]
    v_pk_add_f32 v[52:53], v[52:53], v[100:101]
    v_pk_add_f32 v[54:55], v[54:55], v[70:71]
    v_pk_add_f32 v[52:53], v[52:53], v[68:69]
    v_rcp_f32 v113, v55
    v_cmp_nge_f32 vcc, s72, v55
    v_cmp_nge_f32 s[64:65], s72, v113
    s_waitcnt lgkmcnt(6)
    v_pk_add_f32 v[66:67], v[66:67], v[82:83]
    v_pk_add_f32 v[64:65], v[64:65], v[80:81]
    v_pk_add_f32 v[50:51], v[50:51], v[98:99]
    v_pk_add_f32 v[48:49], v[48:49], v[96:97]
    v_pk_add_f32 v[50:51], v[50:51], v[66:67]
    v_pk_add_f32 v[48:49], v[48:49], v[64:65]
    s_or_b64 vcc, vcc, s[64:65]
    s_cmp_lg_u64 vcc, 0
    s_cselect_b32 s73, 256, 0
    s_cmp_lg_u32 s82, 0
    s_cselect_b32 s73, 0, s73
    s_add_u32 s60, s73, 1
    v_mov_b32 v13, s60
    v_mul_f32 v112, v112, v113
    s_mov_b64 exec, 1
    ds_add_u32 v5, v13 offset:60
    s_mov_b64 exec, -1
    v_pk_mul_f32 v[48:49], v[48:49], v[112:113] op_sel_hi:[1,0]
    v_pk_mul_f32 v[50:51], v[50:51], v[112:113] op_sel_hi:[1,0]
    v_pk_mul_f32 v[52:53], v[52:53], v[112:113] op_sel_hi:[1,0]
    v_pk_mul_f32 v[54:55], v[54:55], v[112:113] op_sel_hi:[1,0]
    v_mov_b32 v55, 1.0
    s_waitcnt lgkmcnt(4)
    v_pk_add_f32 v[74:75], v[74:75], v[90:91]
    v_pk_add_f32 v[72:73], v[72:73], v[88:89]
    v_pk_add_f32 v[58:59], v[58:59], v[106:107]
    v_pk_add_f32 v[56:57], v[56:57], v[104:105]
    v_pk_add_f32 v[58:59], v[58:59], v[74:75]
    v_pk_add_f32 v[56:57], v[56:57], v[72:73]
    s_waitcnt lgkmcnt(1)
    v_pk_add_f32 v[78:79], v[78:79], v[94:95]
    v_pk_add_f32 v[76:77], v[76:77], v[92:93]
    v_pk_add_f32 v[62:63], v[62:63], v[110:111]
    v_pk_add_f32 v[60:61], v[60:61], v[108:109]
    v_pk_add_f32 v[62:63], v[62:63], v[78:79]
    v_pk_add_f32 v[60:61], v[60:61], v[76:77]
    s_wakeup
    v_cvt_pk_bf16_f32 v120, v48, v49
    v_cvt_pk_bf16_f32 v121, v50, v51
    v_cvt_pk_bf16_f32 v122, v52, v53
    v_cvt_pk_bf16_f32 v123, v54, v55
    v_pk_mul_f32 v[56:57], v[56:57], v[112:113] op_sel_hi:[1,0]
    v_pk_mul_f32 v[58:59], v[58:59], v[112:113] op_sel_hi:[1,0]
    v_pk_mul_f32 v[60:61], v[60:61], v[112:113] op_sel_hi:[1,0]
    v_pk_mul_f32 v[62:63], v[62:63], v[112:113] op_sel_hi:[1,0]
    v_mov_b32 v63, 1.0
    ds_read_b32 v12, v5 offset:60
    v_cvt_pk_bf16_f32 v124, v56, v57
    v_cvt_pk_bf16_f32 v125, v58, v59
    v_cvt_pk_bf16_f32 v126, v60, v61
    v_cvt_pk_bf16_f32 v127, v62, v63
    s_or_b32 s60, s73, s71
    s_cbranch_scc1 L_nost
    buffer_store_dwordx4 v[120:123], v2, s[16:19], s3 offen sc1
    buffer_store_dwordx4 v[124:127], v2, s[16:19], s3 offen offset:1024 sc1
    s_mov_b32 s71, 1
L_nost:
    s_wakeup
    s_mov_b32 s61, 300000
    s_mov_b32 s62, 0xff
    s_branch L_fw2
L_fw:
    ds_read_b32 v12, v5 offset:60
L_fw2:
    s_waitcnt lgkmcnt(0)
    v_readfirstlane_b32 s60, v12
    s_sub_u32 s61, s61, 1
    s_cbranch_scc1 L_fd
    s_and_b32 s63, s60, 255
    s_cmp_lt_u32 s63, s78
    s_cbranch_scc1 L_fw
L_fd:
    s_wakeup
    s_lshr_b32 s60, s60, 8
    s_min_u32 s60, s60, 1
    s_andn2_b32 s60, s60, s82
    s_cbranch_scc1 L_redo
    s_cmp_lg_u32 s26, 0
    s_cbranch_scc1 L_fin
    s_mov_b32 s68, 60000
    s_mov_b32 s70, 0x10000
    s_mov_b32 s69, 15
L_ground:
    s_cmp_eq_u32 s62, 0
    s_cbranch_scc1 L_gnp
    s_mov_b64 exec, 0xff
    buffer_load_dword v192, v253, s[16:19], s99 offen sc1
    s_mov_b64 exec, -1
L_gnp:
    s_lshl_b32 s60, s62, 4
    s_or_b32 s60, s60, s69
    s_cmp_eq_u32 s60, 15
    s_cbranch_scc1 L_gfast
    s_mov_b32 s63, 0
    s_bitcmp0_b32 s69, 0
    s_cbranch_scc1 L_gi0
    s_and_b32 s60, s62, 3
    s_cbranch_scc1 L_gi0
    s_bitset1_b32 s63, 0
    s_xor_b32 s60, s100, 0
    s_lshl_b32 s60, s60, 13
    s_add_u32 s66, s97, s60
    s_add_u32 m0, s98, s60
    s_add_u32 s67, s66, 32768
    buffer_load_dwordx4 v2, s[16:19], s66 offen offset:0 sc1 lds
    buffer_load_dwordx4 v2, s[16:19], s66 offen offset:1024 sc1 lds
    s_add_u32 m0, m0, 32768
    s_nop 0
    buffer_load_dwordx4 v2, s[16:19], s67 offen offset:0 sc1 lds
    buffer_load_dwordx4 v2, s[16:19], s67 offen offset:1024 sc1 lds
L_gi0:
    s_bitcmp0_b32 s69, 1
    s_cbranch_scc1 L_gi1
    s_and_b32 s60, s62, 12
    s_cbranch_scc1 L_gi1
    s_bitset1_b32 s63, 1
    s_xor_b32 s60, s100, 1
    s_lshl_b32 s60, s60, 13
    s_add_u32 s66, s97, s60
    s_add_u32 m0, s98, s60
    s_add_u32 s67, s66, 32768
    buffer_load_dwordx4 v2, s[16:19], s66 offen offset:0 sc1 lds
    buffer_load_dwordx4 v2, s[16:19], s66 offen offset:1024 sc1 lds
    s_add_u32 m0, m0, 32768
    s_nop 0
    buffer_load_dwordx4 v2, s[16:19], s67 offen offset:0 sc1 lds
    buffer_load_dwordx4 v2, s[16:19], s67 offen offset:1024 sc1 lds
L_gi1:
    s_bitcmp0_b32 s69, 2
    s_cbranch_scc1 L_gi2
    s_and_b32 s60, s62, 48
    s_cbranch_scc1 L_gi2
    s_bitset1_b32 s63, 2
    s_xor_b32 s60, s100, 2
    s_lshl_b32 s60, s60, 13
    s_add_u32 s66, s97, s60
    s_add_u32 m0, s98, s60
    s_add_u32 s67, s66, 32768
    buffer_load_dwordx4 v2, s[16:19], s66 offen offset:0 sc1 lds
    buffer_load_dwordx4 v2, s[16:19], s66 offen offset:1024 sc1 lds
    s_add_u32 m0, m0, 32768
    s_nop 0
    buffer_load_dwordx4 v2, s[16:19], s67 offen offset:0 sc1 lds
    buffer_load_dwordx4 v2, s[16:19], s67 offen offset:1024 sc1 lds
L_gi2:
    s_bitcmp0_b32 s69, 3
    s_cbranch_scc1 L_gi3
    s_and_b32 s60, s62, 192
    s_cbranch_scc1 L_gi3
    s_bitset1_b32 s63, 3
    s_xor_b32 s60, s100, 3
    s_lshl_b32 s60, s60, 13
    s_add_u32 s66, s97, s60
    s_add_u32 m0, s98, s60
    s_add_u32 s67, s66, 32768
    buffer_load_dwordx4 v2, s[16:19], s66 offen offset:0 sc1 lds
    buffer_load_dwordx4 v2, s[16:19], s66 offen offset:1024 sc1 lds
    s_add_u32 m0, m0, 32768
    s_nop 0
    buffer_load_dwordx4 v2, s[16:19], s67 offen offset:0 sc1 lds
    buffer_load_dwordx4 v2, s[16:19], s67 offen offset:1024 sc1 lds
L_gi3:
    s_sub_u32 s68, s68, 1
    s_cselect_b32 s70, 0, s70
    s_bitcmp0_b32 s63, 0
    s_cbranch_scc1 L_gn0
    s_xor_b32 s64, s100, 0
    s_lshl_b32 s65, s64, 13
    s_add_u32 s65, s65, s98
    v_add_u32 v13, s65, v2
    v_lshl_add_u32 v14, s64, 2, v5
    s_lshr_b32 s60, s63, 1
    s_bcnt1_i32_b32 s60, s60
    s_waitcnt vmcnt(12)
    s_cmp_eq_u32 s60, 3
    s_cbranch_scc1 L_gl0
    s_waitcnt vmcnt(8)
    s_cmp_eq_u32 s60, 2
    s_cbranch_scc1 L_gl0
    s_waitcnt vmcnt(4)
    s_cmp_eq_u32 s60, 1
    s_cbranch_scc1 L_gl0
    s_waitcnt vmcnt(0)
L_gl0:
    ds_read_b32 v176, v13 offset:12
    ds_read_b32 v177, v13 offset:1036
    ds_read_b32 v178, v13 offset:32780
    ds_read_b32 v179, v13 offset:33804
    s_waitcnt lgkmcnt(0)
    v_min3_u32 v12, v176, v177, v178
    v_min_u32 v12, v12, v179
    v_cmp_gt_u32 vcc, s70, v12
    s_nop 0
    s_cmp_lg_u64 vcc, 0
    s_cbranch_scc1 L_gn0
    s_mov_b64 exec, 1
    ds_add_u32 v14, v6 offset:112
    s_mov_b64 exec, -1
    s_bitset0_b32 s69, 0
L_gn0:
    s_bitcmp0_b32 s63, 1
    s_cbranch_scc1 L_gn1
    s_xor_b32 s64, s100, 1
    s_lshl_b32 s65, s64, 13
    s_add_u32 s65, s65, s98
    v_add_u32 v13, s65, v2
    v_lshl_add_u32 v14, s64, 2, v5
    s_lshr_b32 s60, s63, 2
    s_bcnt1_i32_b32 s60, s60
    s_waitcnt vmcnt(8)
    s_cmp_eq_u32 s60, 2
    s_cbranch_scc1 L_gl1
    s_waitcnt vmcnt(4)
    s_cmp_eq_u32 s60, 1
    s_cbranch_scc1 L_gl1
    s_waitcnt vmcnt(0)
L_gl1:
    ds_read_b32 v180, v13 offset:12
    ds_read_b32 v181, v13 offset:1036
    ds_read_b32 v182, v13 offset:32780
    ds_read_b32 v183, v13 offset:33804
    s_waitcnt lgkmcnt(0)
    v_min3_u32 v12, v180, v181, v182
    v_min_u32 v12, v12, v183
    v_cmp_gt_u32 vcc, s70, v12
    s_nop 0
    s_cmp_lg_u64 vcc, 0
    s_cbranch_scc1 L_gn1
    s_mov_b64 exec, 1
    ds_add_u32 v14, v6 offset:112
    s_mov_b64 exec, -1
    s_bitset0_b32 s69, 1
L_gn1:
    s_bitcmp0_b32 s63, 2
    s_cbranch_scc1 L_gn2
    s_xor_b32 s64, s100, 2
    s_lshl_b32 s65, s64, 13
    s_add_u32 s65, s65, s98
    v_add_u32 v13, s65, v2
    v_lshl_add_u32 v14, s64, 2, v5
    s_lshr_b32 s60, s63, 3
    s_bcnt1_i32_b32 s60, s60
    s_waitcnt vmcnt(4)
    s_cmp_eq_u32 s60, 1
    s_cbranch_scc1 L_gl2
    s_waitcnt vmcnt(0)
L_gl2:
    ds_read_b32 v184, v13 offset:12
    ds_read_b32 v185, v13 offset:1036
    ds_read_b32 v186, v13 offset:32780
    ds_read_b32 v187, v13 offset:33804
    s_waitcnt lgkmcnt(0)
    v_min3_u32 v12, v184, v185, v186
    v_min_u32 v12, v12, v187
    v_cmp_gt_u32 vcc, s70, v12
    s_nop 0
    s_cmp_lg_u64 vcc, 0
    s_cbranch_scc1 L_gn2
    s_mov_b64 exec, 1
    ds_add_u32 v14, v6 offset:112
    s_mov_b64 exec, -1
    s_bitset0_b32 s69, 2
L_gn2:
    s_bitcmp0_b32 s63, 3
    s_cbranch_scc1 L_gn3
    s_xor_b32 s64, s100, 3
    s_lshl_b32 s65, s64, 13
    s_add_u32 s65, s65, s98
    v_add_u32 v13, s65, v2
    v_lshl_add_u32 v14, s64, 2, v5
    s_waitcnt vmcnt(0)
L_gl3:
    ds_read_b32 v188, v13 offset:12
    ds_read_b32 v189, v13 offset:1036
    ds_read_b32 v190, v13 offset:32780
    ds_read_b32 v191, v13 offset:33804
    s_waitcnt lgkmcnt(0)
    v_min3_u32 v12, v188, v189, v190
    v_min_u32 v12, v12, v191
    v_cmp_gt_u32 vcc, s70, v12
    s_nop 0
    s_cmp_lg_u64 vcc, 0
    s_cbranch_scc1 L_gn3
    s_mov_b64 exec, 1
    ds_add_u32 v14, v6 offset:112
    s_mov_b64 exec, -1
    s_bitset0_b32 s69, 3
L_gn3:
    s_cmp_eq_u32 s62, 0
    s_cbranch_scc1 L_gnq
    s_waitcnt vmcnt(0)
    s_mov_b64 exec, 0xff
    v_cmp_ne_u32 vcc, s58, v192
    s_mov_b64 exec, -1
    s_cmp_eq_u32 s70, 0
    s_cselect_b32 s62, 0, vcc_lo
L_gnq:
    s_cmp_eq_u32 s69, 0
    s_cbranch_scc1 L_gdone
    s_branch L_ground
L_gdone:
    s_branch L_fin
L_gfast:
    v_add_u32 v13, s98, v2
    s_sub_u32 s68, s68, 1
    s_cselect_b32 s70, 0, s70
    s_add_u32 s66, s97, 0
    s_add_u32 m0, s98, 0
    s_add_u32 s67, s66, 32768
    buffer_load_dwordx4 v2, s[16:19], s66 offen offset:0 sc1 lds
    buffer_load_dwordx4 v2, s[16:19], s66 offen offset:1024 sc1 lds
    s_add_u32 m0, m0, 32768
    s_nop 0
    buffer_load_dwordx4 v2, s[16:19], s67 offen offset:0 sc1 lds
    buffer_load_dwordx4 v2, s[16:19], s67 offen offset:1024 sc1 lds
    s_add_u32 s66, s97, 8192
    s_add_u32 m0, s98, 8192
    s_add_u32 s67, s66, 32768
    buffer_load_dwordx4 v2, s[16:19], s66 offen offset:0 sc1 lds
    buffer_load_dwordx4 v2, s[16:19], s66 offen offset:1024 sc1 lds
    s_add_u32 m0, m0, 32768
    s_nop 0
    buffer_load_dwordx4 v2, s[16:19], s67 offen offset:0 sc1 lds
    buffer_load_dwordx4 v2, s[16:19], s67 offen offset:1024 sc1 lds
    s_waitcnt vmcnt(4)
    ds_read_b32 v176, v13 offset:12
    ds_read_b32 v177, v13 offset:1036
    ds_read_b32 v178, v13 offset:32780
    ds_read_b32 v179, v13 offset:33804
    s_waitcnt lgkmcnt(0)
    v_min3_u32 v12, v176, v177, v178
    v_min_u32 v12, v12, v179
    v_cmp_gt_u32 vcc, s70, v12
    s_nop 0
    s_cmp_lg_u64 vcc, 0
    s_cbranch_scc1 L_gf0
    s_mov_b64 exec, 1
    ds_add_u32 v5, v6 offset:112
    s_mov_b64 exec, -1
    s_bitset0_b32 s69, 0
L_gf0:
    s_add_u32 s66, s97, 16384
    s_add_u32 m0, s98, 16384
    s_add_u32 s67, s66, 32768
    buffer_load_dwordx4 v2, s[16:19], s66 offen offset:0 sc1 lds
    buffer_load_dwordx4 v2, s[16:19], s66 offen offset:1024 sc1 lds
    s_add_u32 m0, m0, 32768
    s_nop 0
    buffer_load_dwordx4 v2, s[16:19], s67 offen offset:0 sc1 lds
    buffer_load_dwordx4 v2, s[16:19], s67 offen offset:1024 sc1 lds
    s_waitcnt vmcnt(4)
    ds_read_b32 v180, v13 offset:8204
    ds_read_b32 v181, v13 offset:9228
    ds_read_b32 v182, v13 offset:40972
    ds_read_b32 v183, v13 offset:41996
    s_waitcnt lgkmcnt(0)
    v_min3_u32 v12, v180, v181, v182
    v_min_u32 v12, v12, v183
    v_cmp_gt_u32 vcc, s70, v12
    s_nop 0
    s_cmp_lg_u64 vcc, 0
    s_cbranch_scc1 L_gf1
    s_mov_b64 exec, 1
    ds_add_u32 v5, v6 offset:116
    s_mov_b64 exec, -1
    s_bitset0_b32 s69, 1
L_gf1:
    s_add_u32 s66, s97, 24576
    s_add_u32 m0, s98, 24576
    s_add_u32 s67, s66, 32768
    buffer_load_dwordx4 v2, s[16:19], s66 offen offset:0 sc1 lds
    buffer_load_dwordx4 v2, s[16:19], s66 offen offset:1024 sc1 lds
    s_add_u32 m0, m0, 32768
    s_nop 0
    buffer_load_dwordx4 v2, s[16:19], s67 offen offset:0 sc1 lds
    buffer_load_dwordx4 v2, s[16:19], s67 offen offset:1024 sc1 lds
    s_waitcnt vmcnt(4)
    ds_read_b32 v184, v13 offset:16396
    ds_read_b32 v185, v13 offset:17420
    ds_read_b32 v186, v13 offset:49164
    ds_read_b32 v187, v13 offset:50188
    s_waitcnt lgkmcnt(0)
    v_min3_u32 v12, v184, v185, v186
    v_min_u32 v12, v12, v187
    v_cmp_gt_u32 vcc, s70, v12
    s_nop 0
    s_cmp_lg_u64 vcc, 0
    s_cbranch_scc1 L_gf2
    s_mov_b64 exec, 1
    ds_add_u32 v5, v6 offset:120
    s_mov_b64 exec, -1
    s_bitset0_b32 s69, 2
L_gf2:
    s_waitcnt vmcnt(0)
    ds_read_b32 v188, v13 offset:24588
    ds_read_b32 v189, v13 offset:25612
    ds_read_b32 v190, v13 offset:57356
    ds_read_b32 v191, v13 offset:58380
    s_waitcnt lgkmcnt(0)
    v_min3_u32 v12, v188, v189, v190
    v_min_u32 v12, v12, v191
    v_cmp_gt_u32 vcc, s70, v12
    s_nop 0
    s_cmp_lg_u64 vcc, 0
    s_cbranch_scc1 L_gf3
    s_mov_b64 exec, 1
    ds_add_u32 v5, v6 offset:124
    s_mov_b64 exec, -1
    s_bitset0_b32 s69, 3
L_gf3:
    s_branch L_gnq
L_wslow:
    s_mov_b32 s61, 300000
lw_26:
    ds_read_b32 v12, v5 offset:24
    s_waitcnt lgkmcnt(0)
    v_readfirstlane_b32 s60, v12
    s_sub_u32 s61, s61, 1
    s_cbranch_scc1 lwd_27
    s_cmp_ge_u32 s60, 8
    s_cbranch_scc1 lwd_27
    s_sleep 1
    s_branch lw_26
lwd_27:
    s_branch L_wok
L_redo:
    s_waitcnt vmcnt(0) lgkmcnt(0)
    s_mov_b32 s82, 1
    s_mov_b32 s78, 8
    s_mov_b32 exec_lo, 0
    v_mov_b32 v22, 0
    v_mov_b32 v30, 0
    v_mov_b32 v38, 0
    v_mov_b32 v46, 0
    s_mov_b32 exec_lo, -1
    v_mov_b32 v244, 0xff800000
    v_mov_b32 v245, 0xff800000
    v_mov_b32 v246, 0xff800000
    v_mov_b32 v247, 0xff800000
    s_mov_b32 s67, s83
    s_mov_b32 s68, 16
L_maxloop:
    buffer_load_dwordx4 v[176:179], v2, s[16:19], s67 offen sc1
    buffer_load_dwordx4 v[180:183], v2, s[16:19], s67 offen offset:1024 sc1
    s_waitcnt vmcnt(0)
    v_mfma_f32_32x32x16_bf16 v[112:127], v[176:179], v[16:19], 0
    v_mfma_f32_32x32x16_bf16 v[112:127], v[180:183], v[20:23], v[112:127]
    v_mfma_f32_32x32x16_bf16 v[128:143], v[176:179], v[24:27], 0
    v_mfma_f32_32x32x16_bf16 v[128:143], v[180:183], v[28:31], v[128:143]
    v_mfma_f32_32x32x16_bf16 v[144:159], v[176:179], v[32:35], 0
    v_mfma_f32_32x32x16_bf16 v[144:159], v[180:183], v[36:39], v[144:159]
    v_mfma_f32_32x32x16_bf16 v[160:175], v[176:179], v[40:43], 0
    v_mfma_f32_32x32x16_bf16 v[160:175], v[180:183], v[44:47], v[160:175]
    s_nop 5
    v_max3_f32 v244, v244, v112, v113
    v_max3_f32 v244, v244, v114, v115
    v_max3_f32 v244, v244, v116, v117
    v_max3_f32 v244, v244, v118, v119
    v_max3_f32 v244, v244, v120, v121
    v_max3_f32 v244, v244, v122, v123
    v_max3_f32 v244, v244, v124, v125
    v_max3_f32 v244, v244, v126, v127
    v_max3_f32 v245, v245, v128, v129
    v_max3_f32 v245, v245, v130, v131
    v_max3_f32 v245, v245, v132, v133
    v_max3_f32 v245, v245, v134, v135
    v_max3_f32 v245, v245, v136, v137
    v_max3_f32 v245, v245, v138, v139
    v_max3_f32 v245, v245, v140, v141
    v_max3_f32 v245, v245, v142, v143
    v_max3_f32 v246, v246, v144, v145
    v_max3_f32 v246, v246, v146, v147
    v_max3_f32 v246, v246, v148, v149
    v_max3_f32 v246, v246, v150, v151
    v_max3_f32 v246, v246, v152, v153
    v_max3_f32 v246, v246, v154, v155
    v_max3_f32 v246, v246, v156, v157
    v_max3_f32 v246, v246, v158, v159
    v_max3_f32 v247, v247, v160, v161
    v_max3_f32 v247, v247, v162, v163
    v_max3_f32 v247, v247, v164, v165
    v_max3_f32 v247, v247, v166, v167
    v_max3_f32 v247, v247, v168, v169
    v_max3_f32 v247, v247, v170, v171
    v_max3_f32 v247, v247, v172, v173
    v_max3_f32 v247, v247, v174, v175
    s_add_u32 s67, s67, 4096
    s_sub_u32 s68, s68, 1
    s_cmp_lg_u32 s68, 0
    s_cbranch_scc1 L_maxloop
    v_mov_b32 v248, v244
    s_nop 1
    v_permlane32_swap_b32 v244, v248
    v_max_f32 v244, v244, v248
    v_mov_b32 v249, v245
    s_nop 1
    v_permlane32_swap_b32 v245, v249
    v_max_f32 v245, v245, v249
    v_mov_b32 v250, v246
    s_nop 1
    v_permlane32_swap_b32 v246, v250
    v_max_f32 v246, v246, v250
    v_mov_b32 v251, v247
    s_nop 1
    v_permlane32_swap_b32 v247, v251
    v_max_f32 v247, v247, v251
    v_lshlrev_b32 v14, 2, v0
    s_add_u32 s64, s25, 0
    s_and_b32 s64, s64, 3
    s_lshl_b32 s64, s64, 10
    s_add_u32 s64, s64, 140288
    v_add_u32 v112, s64, v14
    s_lshl_b32 s65, s25, 8
    v_add_u32 v13, s65, v112
    ds_write_b32 v13, v244
    s_add_u32 s64, s25, 1
    s_and_b32 s64, s64, 3
    s_lshl_b32 s64, s64, 10
    s_add_u32 s64, s64, 140288
    v_add_u32 v113, s64, v14
    s_lshl_b32 s65, s25, 8
    v_add_u32 v13, s65, v113
    ds_write_b32 v13, v245
    s_add_u32 s64, s25, 2
    s_and_b32 s64, s64, 3
    s_lshl_b32 s64, s64, 10
    s_add_u32 s64, s64, 140288
    v_add_u32 v114, s64, v14
    s_lshl_b32 s65, s25, 8
    v_add_u32 v13, s65, v114
    ds_write_b32 v13, v246
    s_add_u32 s64, s25, 3
    s_and_b32 s64, s64, 3
    s_lshl_b32 s64, s64, 10
    s_add_u32 s64, s64, 140288
    v_add_u32 v115, s64, v14
    s_lshl_b32 s65, s25, 8
    v_add_u32 v13, s65, v115
    ds_write_b32 v13, v247
    s_waitcnt lgkmcnt(0)
    s_mov_b64 exec, 1
    ds_add_u32 v5, v6 offset:20
    s_mov_b64 exec, -1
    s_mov_b32 s61, 300000
lw_28:
    ds_read_b32 v12, v5 offset:20
    s_waitcnt lgkmcnt(0)
    v_readfirstlane_b32 s60, v12
    s_sub_u32 s61, s61, 1
    s_cbranch_scc1 lwd_29
    s_cmp_ge_u32 s60, 4
    s_cbranch_scc1 lwd_29
    s_branch lw_28
lwd_29:
    ds_read_b32 v128, v112 offset:0
    ds_read_b32 v129, v112 offset:256
    ds_read_b32 v130, v112 offset:512
    ds_read_b32 v131, v112 offset:768
    s_waitcnt lgkmcnt(0)
    v_max3_f32 v244, v128, v129, v130
    v_max_f32 v244, v244, v131
    ds_read_b32 v132, v113 offset:0
    ds_read_b32 v133, v113 offset:256
    ds_read_b32 v134, v113 offset:512
    ds_read_b32 v135, v113 offset:768
    s_waitcnt lgkmcnt(0)
    v_max3_f32 v245, v132, v133, v134
    v_max_f32 v245, v245, v135
    ds_read_b32 v136, v114 offset:0
    ds_read_b32 v137, v114 offset:256
    ds_read_b32 v138, v114 offset:512
    ds_read_b32 v139, v114 offset:768
    s_waitcnt lgkmcnt(0)
    v_max3_f32 v246, v136, v137, v138
    v_max_f32 v246, v246, v139
    ds_read_b32 v140, v115 offset:0
    ds_read_b32 v141, v115 offset:256
    ds_read_b32 v142, v115 offset:512
    ds_read_b32 v143, v115 offset:768
    s_waitcnt lgkmcnt(0)
    v_max3_f32 v247, v140, v141, v142
    v_max_f32 v247, v247, v143
    v_cvt_pk_bf16_f32 v248, v244, v244
    v_cvt_pk_bf16_f32 v249, v245, v245
    v_cvt_pk_bf16_f32 v250, v246, v246
    v_cvt_pk_bf16_f32 v251, v247, v247
    v_lshlrev_b32 v248, 16, v248
    v_lshlrev_b32 v249, 16, v249
    v_lshlrev_b32 v250, 16, v250
    v_lshlrev_b32 v251, 16, v251
    v_sub_f32 v244, v244, v248
    v_sub_f32 v245, v245, v249
    v_sub_f32 v246, v246, v250
    v_sub_f32 v247, v247, v251
    s_mov_b32 exec_lo, 0
    v_cvt_pk_bf16_f32 v22, -v248, -v244
    v_cvt_pk_bf16_f32 v30, -v249, -v245
    v_cvt_pk_bf16_f32 v38, -v250, -v246
    v_cvt_pk_bf16_f32 v46, -v251, -v247
    s_mov_b32 exec_lo, -1
    v_mov_b32 v48, 0
    v_mov_b32 v49, 0
    v_mov_b32 v50, 0
    v_mov_b32 v51, 0
    v_mov_b32 v52, 0
    v_mov_b32 v53, 0
    v_mov_b32 v54, 0
    v_mov_b32 v55, 0
    v_mov_b32 v56, 0
    v_mov_b32 v57, 0
    v_mov_b32 v58, 0
    v_mov_b32 v59, 0
    v_mov_b32 v60, 0
    v_mov_b32 v61, 0
    v_mov_b32 v62, 0
    v_mov_b32 v63, 0
    v_mov_b32 v64, 0
    v_mov_b32 v65, 0
    v_mov_b32 v66, 0
    v_mov_b32 v67, 0
    v_mov_b32 v68, 0
    v_mov_b32 v69, 0
    v_mov_b32 v70, 0
    v_mov_b32 v71, 0
    v_mov_b32 v72, 0
    v_mov_b32 v73, 0
    v_mov_b32 v74, 0
    v_mov_b32 v75, 0
    v_mov_b32 v76, 0
    v_mov_b32 v77, 0
    v_mov_b32 v78, 0
    v_mov_b32 v79, 0
    v_mov_b32 v80, 0
    v_mov_b32 v81, 0
    v_mov_b32 v82, 0
    v_mov_b32 v83, 0
    v_mov_b32 v84, 0
    v_mov_b32 v85, 0
    v_mov_b32 v86, 0
    v_mov_b32 v87, 0
    v_mov_b32 v88, 0
    v_mov_b32 v89, 0
    v_mov_b32 v90, 0
    v_mov_b32 v91, 0
    v_mov_b32 v92, 0
    v_mov_b32 v93, 0
    v_mov_b32 v94, 0
    v_mov_b32 v95, 0
    v_mov_b32 v96, 0
    v_mov_b32 v97, 0
    v_mov_b32 v98, 0
    v_mov_b32 v99, 0
    v_mov_b32 v100, 0
    v_mov_b32 v101, 0
    v_mov_b32 v102, 0
    v_mov_b32 v103, 0
    v_mov_b32 v104, 0
    v_mov_b32 v105, 0
    v_mov_b32 v106, 0
    v_mov_b32 v107, 0
    v_mov_b32 v108, 0
    v_mov_b32 v109, 0
    v_mov_b32 v110, 0
    v_mov_b32 v111, 0
    v_mov_b32 v236, 0
    v_mov_b32 v237, 0
    v_mov_b32 v238, 0
    v_mov_b32 v239, 0
    s_add_u32 s64, s83, 0
    buffer_load_dwordx4 v[176:179], v2, s[16:19], s64 offen sc1
    buffer_load_dwordx4 v[180:183], v2, s[16:19], s64 offen offset:1024 sc1
    s_add_u32 s64, s83, 0
    buffer_load_dwordx4 v[208:211], v2, s[16:19], s64 offen offset:2048 sc1
    buffer_load_dwordx4 v[212:215], v2, s[16:19], s64 offen offset:3072 sc1
    s_add_u32 s64, s83, 4096
    buffer_load_dwordx4 v[184:187], v2, s[16:19], s64 offen sc1
    buffer_load_dwordx4 v[188:191], v2, s[16:19], s64 offen offset:1024 sc1
    s_add_u32 s64, s83, 4096
    buffer_load_dwordx4 v[216:219], v2, s[16:19], s64 offen offset:2048 sc1
    buffer_load_dwordx4 v[220:223], v2, s[16:19], s64 offen offset:3072 sc1
    s_add_u32 s64, s83, 8192
    buffer_load_dwordx4 v[192:195], v2, s[16:19], s64 offen sc1
    buffer_load_dwordx4 v[196:199], v2, s[16:19], s64 offen offset:1024 sc1
    s_add_u32 s64, s83, 8192
    buffer_load_dwordx4 v[224:227], v2, s[16:19], s64 offen offset:2048 sc1
    buffer_load_dwordx4 v[228:231], v2, s[16:19], s64 offen offset:3072 sc1
    s_add_u32 s64, s83, 12288
    buffer_load_dwordx4 v[200:203], v2, s[16:19], s64 offen sc1
    buffer_load_dwordx4 v[204:207], v2, s[16:19], s64 offen offset:1024 sc1
    s_branch L_start
L_g1:
    s_mov_b32 s67, s75
    s_waitcnt lgkmcnt(0)
    s_setprio 1
    s_mov_b32 s16, s56
    s_mov_b32 s17, s57
    s_mov_b32 s18, 268435456
    s_mov_b32 s19, 0x00020000
    s_add_u32 s64, s56, 655360
    s_addc_u32 s65, s57, 0
    s_load_dword s58, s[64:65], 0
    s_mov_b32 s12, s34
    s_mov_b32 s13, s35
    s_mov_b32 s14, 1204224
    s_mov_b32 s15, 0x00020000
    s_barrier
    v_and_b32 v3, 31, v0
    v_bfe_u32 v7, v0, 4, 1
    v_and_b32 v12, 3, v0
    v_lshl_add_u32 v7, v7, 2, v12
    v_cmp_lt_u32 vcc, 5, v7
    v_xor_b32 v12, 1, v7
    s_nop 0
    v_cndmask_b32 v7, v7, v12, vcc
    v_lshlrev_b32 v7, 3, v7
    v_bfe_u32 v12, v0, 1, 3
    v_xor_b32 v12, v12, v4
    v_lshlrev_b32 v12, 4, v12
    v_lshl_add_u32 v40, v3, 7, v12
    v_add_u32 v40, s76, v40
    v_xor_b32 v41, 32, v40
    v_xor_b32 v42, 64, v40
    v_xor_b32 v43, 96, v40
    v_add_u32 v20, s76, v2
    v_lshl_add_u32 v22, s25, 2, v5
    v_bfe_u32 v21, v0, 2, 2
    v_lshl_add_u32 v21, v4, 3, v21
    v_lshlrev_b32 v21, 6, v21
    v_add_u32 v21, v21, v7
    v_add_u32 v17, 65536, v21
    v_add_u32 v11, 122880, v21
    s_lshl_b32 s64, s25, 8
    s_add_u32 s64, s64, 155648
    v_lshl_add_u32 v16, v0, 2, s64
    s_mov_b32 s70, 0x3e8b97f6
    v_and_b32 v12, 15, v0
    s_lshl_b32 s60, s30, 4
    v_add_u32 v19, s60, v12
    v_lshlrev_b32 v19, 7, v19
    s_lshl_b32 s60, s93, 3
    v_add_u32 v19, s60, v19
    v_lshrrev_b32 v12, 3, v0
    v_and_b32 v13, 7, v0
    v_bfe_u32 v14, v0, 4, 1
    v_lshlrev_b32 v14, 2, v14
    v_xor_b32 v13, v13, v14
    v_lshlrev_b32 v13, 4, v13
    v_mul_u32_u24 v23, 896, v12
    v_add_u32 v23, v23, v13
    v_bfe_u32 v12, v0, 2, 2
    v_lshl_add_u32 v8, v4, 2, v12
    v_lshlrev_b32 v8, 7, v8
    v_lshrrev_b32 v12, 1, v12
    v_xor_b32 v12, s29, v12
    v_lshl_add_u32 v8, v12, 6, v8
    v_bfe_u32 v12, v0, 4, 1
    v_lshl_add_u32 v8, v12, 5, v8
    v_and_b32 v12, 3, v0
    v_lshl_add_u32 v8, v12, 3, v8
    v_bfe_u32 v12, v0, 2, 2
    v_mul_u32_u24 v13, 7, v4
    v_add_u32 v12, v12, v13
    v_lshlrev_b32 v9, 7, v12
    v_bfe_u32 v12, v12, 1, 1
    v_xor_b32 v12, s29, v12
    v_lshl_add_u32 v9, v12, 6, v9
    v_and_b32 v12, 63, v8
    v_add_u32 v9, v9, v12
    v_add_u32 v9, 58368, v9
    v_lshl_add_u32 v8, v23, 16, v8
    s_waitcnt lgkmcnt(0)
    s_add_u32 s58, s58, 0x9e3779b9
    s_cmp_lg_u32 s26, 0
    s_cbranch_scc1 L_g1_job
    s_mov_b32 s61, 300000
lw_30:
    ds_read_b32 v12, v5 offset:128
    s_waitcnt lgkmcnt(0)
    v_readfirstlane_b32 s60, v12
    s_sub_u32 s61, s61, 1
    s_cbranch_scc1 lwd_31
    s_cmp_ge_u32 s60, 4
    s_cbranch_scc1 lwd_31
    s_branch lw_30
lwd_31:
    ds_read_b128 v[64:67], v40 offset:0
    ds_read_b128 v[68:71], v41 offset:0
    ds_read_b128 v[72:75], v42 offset:0
    ds_read_b128 v[76:79], v43 offset:0
    s_mov_b64 exec, 1
    ds_add_u32 v5, v6 offset:160
    s_mov_b64 exec, -1
    ds_read_b64_tr_b16 v[176:177], v17 offset:0
    ds_read_b64_tr_b16 v[178:179], v17 offset:256
    ds_read_b64_tr_b16 v[180:181], v17 offset:28672
    ds_read_b64_tr_b16 v[182:183], v17 offset:28928
    ds_read_b64_tr_b16 v[184:185], v17 offset:1024
    ds_read_b64_tr_b16 v[186:187], v17 offset:1280
    ds_read_b64_tr_b16 v[188:189], v17 offset:29696
    ds_read_b64_tr_b16 v[190:191], v17 offset:29952
    ds_read_b64_tr_b16 v[192:193], v17 offset:2048
    ds_read_b64_tr_b16 v[194:195], v17 offset:2304
    ds_read_b64_tr_b16 v[196:197], v17 offset:30720
    ds_read_b64_tr_b16 v[198:199], v17 offset:30976
    ds_read_b64_tr_b16 v[200:201], v17 offset:3072
    ds_read_b64_tr_b16 v[202:203], v17 offset:3328
    ds_read_b64_tr_b16 v[204:205], v17 offset:31744
    ds_read_b64_tr_b16 v[206:207], v17 offset:32000
    ds_read_b32 v13, v5 offset:132
    s_waitcnt lgkmcnt(0)
    v_readfirstlane_b32 s60, v13
    v_mfma_f32_32x32x16_bf16 v[224:239], v[176:179], v[64:67], 0
    s_cmp_ge_u32 s60, 4
    s_cbranch_scc0 fslow_32
    ds_read_b128 v[80:83], v40 offset:4096
    ds_read_b128 v[84:87], v41 offset:4096
    ds_read_b128 v[88:91], v42 offset:4096
    ds_read_b128 v[92:95], v43 offset:4096
    v_mfma_f32_32x32x16_bf16 v[240:255], v[180:183], v[64:67], 0
    s_mov_b64 exec, 1
    ds_add_u32 v5, v6 offset:164
    s_mov_b64 exec, -1
    ds_read_b64_tr_b16 v[208:209], v17 offset:4096
    ds_read_b64_tr_b16 v[210:211], v17 offset:4352
    ds_read_b64_tr_b16 v[212:213], v17 offset:32768
    v_mfma_f32_32x32x16_bf16 v[224:239], v[184:187], v[68:71], v[224:239]
    ds_read_b64_tr_b16 v[214:215], v17 offset:33024
    ds_read_b64_tr_b16 v[216:217], v17 offset:5120
    ds_read_b64_tr_b16 v[218:219], v17 offset:5376
    ds_read_b64_tr_b16 v[220:221], v17 offset:33792
    v_mfma_f32_32x32x16_bf16 v[240:255], v[188:191], v[68:71], v[240:255]
    ds_read_b64_tr_b16 v[222:223], v17 offset:34048
    ds_read_b64_tr_b16 v[48:49], v17 offset:6144
    ds_read_b64_tr_b16 v[50:51], v17 offset:6400
    ds_read_b64_tr_b16 v[52:53], v17 offset:34816
    v_mfma_f32_32x32x16_bf16 v[224:239], v[192:195], v[72:75], v[224:239]
    ds_read_b64_tr_b16 v[54:55], v17 offset:35072
    ds_read_b64_tr_b16 v[56:57], v17 offset:7168
    ds_read_b64_tr_b16 v[58:59], v17 offset:7424
    ds_read_b64_tr_b16 v[60:61], v17 offset:35840
    v_mfma_f32_32x32x16_bf16 v[240:255], v[196:199], v[72:75], v[240:255]
    ds_read_b64_tr_b16 v[62:63], v17 offset:36096
    ds_read_b32 v13, v5 offset:136
    v_mfma_f32_32x32x16_bf16 v[224:239], v[200:203], v[76:79], v[224:239]
    v_mfma_f32_32x32x16_bf16 v[240:255], v[204:207], v[76:79], v[240:255]
fok_33:
    s_waitcnt lgkmcnt(0)
    v_readfirstlane_b32 s60, v13
    v_mfma_f32_32x32x16_bf16 v[224:239], v[208:211], v[80:83], v[224:239]
    s_cmp_ge_u32 s60, 4
    s_cbranch_scc0 fslow_34
    ds_read_b128 v[96:99], v40 offset:8192
    ds_read_b128 v[100:103], v41 offset:8192
    ds_read_b128 v[104:107], v42 offset:8192
    ds_read_b128 v[108:111], v43 offset:8192
    v_mfma_f32_32x32x16_bf16 v[240:255], v[212:215], v[80:83], v[240:255]
    s_mov_b64 exec, 1
    ds_add_u32 v5, v6 offset:168
    s_mov_b64 exec, -1
    ds_read_b64_tr_b16 v[176:177], v17 offset:8192
    ds_read_b64_tr_b16 v[178:179], v17 offset:8448
    ds_read_b64_tr_b16 v[180:181], v17 offset:36864
    v_mfma_f32_32x32x16_bf16 v[224:239], v[216:219], v[84:87], v[224:239]
    ds_read_b64_tr_b16 v[182:183], v17 offset:37120
    ds_read_b64_tr_b16 v[184:185], v17 offset:9216
    ds_read_b64_tr_b16 v[186:187], v17 offset:9472
    ds_read_b64_tr_b16 v[188:189], v17 offset:37888
    v_mfma_f32_32x32x16_bf16 v[240:255], v[220:223], v[84:87], v[240:255]
    ds_read_b64_tr_b16 v[190:191], v17 offset:38144
    ds_read_b64_tr_b16 v[192:193], v17 offset:10240
    ds_read_b64_tr_b16 v[194:195], v17 offset:10496
    ds_read_b64_tr_b16 v[196:197], v17 offset:38912
    v_mfma_f32_32x32x16_bf16 v[224:239], v[48:51], v[88:91], v[224:239]
    ds_read_b64_tr_b16 v[198:199], v17 offset:39168
    ds_read_b64_tr_b16 v[200:201], v17 offset:11264
    ds_read_b64_tr_b16 v[202:203], v17 offset:11520
    ds_read_b64_tr_b16 v[204:205], v17 offset:39936
    v_mfma_f32_32x32x16_bf16 v[240:255], v[52:55], v[88:91], v[240:255]
    ds_read_b64_tr_b16 v[206:207], v17 offset:40192
    ds_read_b32 v13, v5 offset:140
    v_mfma_f32_32x32x16_bf16 v[224:239], v[56:59], v[92:95], v[224:239]
    v_mfma_f32_32x32x16_bf16 v[240:255], v[60:63], v[92:95], v[240:255]
fok_35:
    s_waitcnt lgkmcnt(0)
    v_readfirstlane_b32 s60, v13
    v_mfma_f32_32x32x16_bf16 v[224:239], v[176:179], v[96:99], v[224:239]
    s_cmp_ge_u32 s60, 4
    s_cbranch_scc0 fslow_36
    ds_read_b128 v[112:115], v40 offset:12288
    ds_read_b128 v[116:119], v41 offset:12288
    ds_read_b128 v[120:123], v42 offset:12288
    v_mfma_f32_32x32x16_bf16 v[240:255], v[180:183], v[96:99], v[240:255]
    ds_read_b128 v[124:127], v43 offset:12288
    ds_read_b64_tr_b16 v[208:209], v17 offset:12288
    ds_read_b64_tr_b16 v[210:211], v17 offset:12544
    v_mfma_f32_32x32x16_bf16 v[224:239], v[184:187], v[100:103], v[224:239]
    ds_read_b64_tr_b16 v[212:213], v17 offset:40960
    ds_read_b64_tr_b16 v[214:215], v17 offset:41216
    ds_read_b64_tr_b16 v[216:217], v17 offset:13312
    v_mfma_f32_32x32x16_bf16 v[240:255], v[188:191], v[100:103], v[240:255]
    ds_read_b64_tr_b16 v[218:219], v17 offset:13568
    ds_read_b64_tr_b16 v[220:221], v17 offset:41984
    ds_read_b64_tr_b16 v[222:223], v17 offset:42240
    v_mfma_f32_32x32x16_bf16 v[224:239], v[192:195], v[104:107], v[224:239]
    ds_read_b64_tr_b16 v[48:49], v17 offset:14336
    ds_read_b64_tr_b16 v[50:51], v17 offset:14592
    ds_read_b64_tr_b16 v[52:53], v17 offset:43008
    v_mfma_f32_32x32x16_bf16 v[240:255], v[196:199], v[104:107], v[240:255]
    ds_read_b64_tr_b16 v[54:55], v17 offset:43264
    ds_read_b64_tr_b16 v[56:57], v17 offset:15360
    ds_read_b64_tr_b16 v[58:59], v17 offset:15616
    v_mfma_f32_32x32x16_bf16 v[224:239], v[200:203], v[108:111], v[224:239]
    ds_read_b64_tr_b16 v[60:61], v17 offset:44032
    ds_read_b64_tr_b16 v[62:63], v17 offset:44288
    ds_read_b32 v13, v5 offset:144
    v_mfma_f32_32x32x16_bf16 v[240:255], v[204:207], v[108:111], v[240:255]
fok_37:
    s_waitcnt lgkmcnt(0)
    v_readfirstlane_b32 s60, v13
    v_mfma_f32_32x32x16_bf16 v[224:239], v[208:211], v[112:115], v[224:239]
    s_cmp_ge_u32 s60, 4
    s_cbranch_scc0 fslow_38
    ds_read_b128 v[128:131], v40 offset:0
    ds_read_b128 v[132:135], v41 offset:0
    ds_read_b128 v[136:139], v42 offset:0
    v_mfma_f32_32x32x16_bf16 v[240:255], v[212:215], v[112:115], v[240:255]
    ds_read_b128 v[140:143], v43 offset:0
    ds_read_b64_tr_b16 v[176:177], v17 offset:16384
    ds_read_b64_tr_b16 v[178:179], v17 offset:16640
    v_mfma_f32_32x32x16_bf16 v[224:239], v[216:219], v[116:119], v[224:239]
    ds_read_b64_tr_b16 v[180:181], v17 offset:45056
    ds_read_b64_tr_b16 v[182:183], v17 offset:45312
    ds_read_b64_tr_b16 v[184:185], v17 offset:17408
    v_mfma_f32_32x32x16_bf16 v[240:255], v[220:223], v[116:119], v[240:255]
    ds_read_b64_tr_b16 v[186:187], v17 offset:17664
    ds_read_b64_tr_b16 v[188:189], v17 offset:46080
    ds_read_b64_tr_b16 v[190:191], v17 offset:46336
    v_mfma_f32_32x32x16_bf16 v[224:239], v[48:51], v[120:123], v[224:239]
    ds_read_b64_tr_b16 v[192:193], v17 offset:18432
    ds_read_b64_tr_b16 v[194:195], v17 offset:18688
    ds_read_b64_tr_b16 v[196:197], v17 offset:47104
    v_mfma_f32_32x32x16_bf16 v[240:255], v[52:55], v[120:123], v[240:255]
    ds_read_b64_tr_b16 v[198:199], v17 offset:47360
    ds_read_b64_tr_b16 v[200:201], v17 offset:19456
    ds_read_b64_tr_b16 v[202:203], v17 offset:19712
    v_mfma_f32_32x32x16_bf16 v[224:239], v[56:59], v[124:127], v[224:239]
    ds_read_b64_tr_b16 v[204:205], v17 offset:48128
    ds_read_b64_tr_b16 v[206:207], v17 offset:48384
    ds_read_b32 v13, v5 offset:148
    v_mfma_f32_32x32x16_bf16 v[240:255], v[60:63], v[124:127], v[240:255]
fok_39:
    s_waitcnt lgkmcnt(0)
    v_readfirstlane_b32 s60, v13
    v_mfma_f32_32x32x16_bf16 v[224:239], v[176:179], v[128:131], v[224:239]
    s_cmp_ge_u32 s60, 4
    s_cbranch_scc0 fslow_40
    ds_read_b128 v[144:147], v40 offset:4096
    ds_read_b128 v[148:151], v41 offset:4096
    ds_read_b128 v[152:155], v42 offset:4096
    v_mfma_f32_32x32x16_bf16 v[240:255], v[180:183], v[128:131], v[240:255]
    ds_read_b128 v[156:159], v43 offset:4096
    ds_read_b64_tr_b16 v[208:209], v17 offset:20480
    ds_read_b64_tr_b16 v[210:211], v17 offset:20736
    v_mfma_f32_32x32x16_bf16 v[224:239], v[184:187], v[132:135], v[224:239]
    ds_read_b64_tr_b16 v[212:213], v17 offset:49152
    ds_read_b64_tr_b16 v[214:215], v17 offset:49408
    ds_read_b64_tr_b16 v[216:217], v17 offset:21504
    v_mfma_f32_32x32x16_bf16 v[240:255], v[188:191], v[132:135], v[240:255]
    ds_read_b64_tr_b16 v[218:219], v17 offset:21760
    ds_read_b64_tr_b16 v[220:221], v17 offset:50176
    ds_read_b64_tr_b16 v[222:223], v17 offset:50432
    v_mfma_f32_32x32x16_bf16 v[224:239], v[192:195], v[136:139], v[224:239]
    ds_read_b64_tr_b16 v[48:49], v17 offset:22528
    ds_read_b64_tr_b16 v[50:51], v17 offset:22784
    ds_read_b64_tr_b16 v[52:53], v17 offset:51200
    v_mfma_f32_32x32x16_bf16 v[240:255], v[196:199], v[136:139], v[240:255]
    ds_read_b64_tr_b16 v[54:55], v17 offset:51456
    ds_read_b64_tr_b16 v[56:57], v17 offset:23552
    ds_read_b64_tr_b16 v[58:59], v17 offset:23808
    v_mfma_f32_32x32x16_bf16 v[224:239], v[200:203], v[140:143], v[224:239]
    ds_read_b64_tr_b16 v[60:61], v17 offset:52224
    ds_read_b64_tr_b16 v[62:63], v17 offset:52480
    ds_read_b32 v13, v5 offset:152
    v_mfma_f32_32x32x16_bf16 v[240:255], v[204:207], v[140:143], v[240:255]
fok_41:
    s_waitcnt lgkmcnt(0)
    v_readfirstlane_b32 s60, v13
    v_mfma_f32_32x32x16_bf16 v[224:239], v[208:211], v[144:147], v[224:239]
    s_cmp_ge_u32 s60, 4
    s_cbranch_scc0 fslow_42
    ds_read_b128 v[160:163], v40 offset:8192
    ds_read_b128 v[164:167], v41 offset:8192
    ds_read_b128 v[168:171], v42 offset:8192
    v_mfma_f32_32x32x16_bf16 v[240:255], v[212:215], v[144:147], v[240:255]
    ds_read_b128 v[172:175], v43 offset:8192
    s_mov_b64 exec, 1
    ds_add_u32 v5, v6 offset:172
    s_mov_b64 exec, -1
    ds_read_b64_tr_b16 v[176:177], v17 offset:24576
    v_mfma_f32_32x32x16_bf16 v[224:239], v[216:219], v[148:151], v[224:239]
    ds_read_b64_tr_b16 v[178:179], v17 offset:24832
    ds_read_b64_tr_b16 v[180:181], v17 offset:53248
    ds_read_b64_tr_b16 v[182:183], v17 offset:53504
    v_mfma_f32_32x32x16_bf16 v[240:255], v[220:223], v[148:151], v[240:255]
    ds_read_b64_tr_b16 v[184:185], v17 offset:25600
    ds_read_b64_tr_b16 v[186:187], v17 offset:25856
    ds_read_b64_tr_b16 v[188:189], v17 offset:54272
    v_mfma_f32_32x32x16_bf16 v[224:239], v[48:51], v[152:155], v[224:239]
    ds_read_b64_tr_b16 v[190:191], v17 offset:54528
    ds_read_b64_tr_b16 v[192:193], v17 offset:26624
    ds_read_b64_tr_b16 v[194:195], v17 offset:26880
    v_mfma_f32_32x32x16_bf16 v[240:255], v[52:55], v[152:155], v[240:255]
    ds_read_b64_tr_b16 v[196:197], v17 offset:55296
    ds_read_b64_tr_b16 v[198:199], v17 offset:55552
    ds_read_b64_tr_b16 v[200:201], v17 offset:27648
    v_mfma_f32_32x32x16_bf16 v[224:239], v[56:59], v[156:159], v[224:239]
    ds_read_b64_tr_b16 v[202:203], v17 offset:27904
    ds_read_b64_tr_b16 v[204:205], v17 offset:56320
    ds_read_b64_tr_b16 v[206:207], v17 offset:56576
    v_mfma_f32_32x32x16_bf16 v[240:255], v[60:63], v[156:159], v[240:255]
fok_43:
    s_waitcnt lgkmcnt(0)
    v_mfma_f32_32x32x16_bf16 v[224:239], v[176:179], v[160:163], v[224:239]
    v_mfma_f32_32x32x16_bf16 v[224:239], v[184:187], v[164:167], v[224:239]
    v_mfma_f32_32x32x16_bf16 v[224:239], v[192:195], v[168:171], v[224:239]
    v_mfma_f32_32x32x16_bf16 v[224:239], v[200:203], v[172:175], v[224:239]
    v_mfma_f32_32x32x16_bf16 v[240:255], v[180:183], v[160:163], v[240:255]
    v_mfma_f32_32x32x16_bf16 v[240:255], v[188:191], v[164:167], v[240:255]
    v_mfma_f32_32x32x16_bf16 v[240:255], v[196:199], v[168:171], v[240:255]
    s_nop 8
    v_cvt_pk_bf16_f32 v32, v224, v225
    v_cvt_pk_bf16_f32 v33, v226, v227
    v_cvt_pk_bf16_f32 v34, v228, v229
    v_cvt_pk_bf16_f32 v35, v230, v231
    v_mfma_f32_32x32x16_bf16 v[240:255], v[204:207], v[172:175], v[240:255]
    v_cvt_pk_bf16_f32 v36, v232, v233
    v_cvt_pk_bf16_f32 v37, v234, v235
    v_cvt_pk_bf16_f32 v38, v236, v237
    v_cvt_pk_bf16_f32 v39, v238, v239
    ds_write_b128 v20, v[32:35] offset:12288
    ds_write_b128 v20, v[36:39] offset:13312
    ds_write_b32 v22, v6 offset:176
    s_nop 4
    v_mul_f32 v18, 0xbfb8aa3b, v252
    v_exp_f32 v18, v18
    v_mul_f32 v14, v240, v240
    v_mul_f32 v23, v241, v241
    v_fmac_f32 v14, v242, v242
    v_fmac_f32 v23, v243, v243
    v_fmac_f32 v14, v244, v244
    v_fmac_f32 v23, v245, v245
    v_fmac_f32 v14, v246, v246
    v_fmac_f32 v23, v247, v247
    v_fmac_f32 v14, v248, v248
    v_fmac_f32 v23, v249, v249
    v_fmac_f32 v14, v250, v250
    v_fmac_f32 v23, v251, v251
    s_mov_b32 exec_hi, 0
    v_fmac_f32 v14, v252, v252
    v_fmac_f32 v23, v253, v253
    v_fmac_f32 v14, v254, v254
    v_fmac_f32 v23, v255, v255
    s_mov_b32 exec_hi, -1
    v_add_f32 v14, v14, v23
    v_mov_b32 v23, v14
    s_nop 1
    v_permlane32_swap_b32 v14, v23
    v_add_f32 v14, v14, v23
    v_sqrt_f32 v14, v14
    v_add_f32 v18, 1.0, v18
    v_rcp_f32 v18, v18
    v_cvt_pk_bf16_f32 v24, v240, v241
    v_cvt_pk_bf16_f32 v25, v242, v243
    v_cvt_pk_bf16_f32 v26, v244, v245
    v_cvt_pk_bf16_f32 v27, v246, v247
    v_cvt_pk_bf16_f32 v28, v248, v249
    v_cvt_pk_bf16_f32 v29, v250, v251
    v_cvt_pk_bf16_f32 v30, v252, v253
    v_cvt_pk_bf16_f32 v31, v254, v255
    v_mov_b32 v23, v18
    s_mov_b32 exec_lo, 0
    v_mov_b32 v31, v14
    s_mov_b32 exec_lo, -1
    v_permlane32_swap_b32 v23, v18
    ds_write_b128 v20, v[24:27] offset:14336
    ds_write_b128 v20, v[28:31] offset:15360
    ds_write_b32 v16, v18
    s_mov_b64 exec, 1
    ds_add_u32 v5, v6 offset:4
    s_mov_b64 exec, -1
    s_mul_i32 s64, s67, 172032
    s_add_u32 s64, s64, s96
    s_add_u32 m0, s76, 0
    s_nop 0
    buffer_load_dwordx4 v10, s[12:15], s64 offen lds
    s_add_u32 s67, s67, 1
    s_cmp_eq_u32 s67, 7
    s_cselect_b32 s67, 0, s67
    s_mul_i32 s64, s67, 172032
    s_add_u32 s64, s64, s96
    s_add_u32 m0, s76, 1024
    s_nop 0
    buffer_load_dwordx4 v10, s[12:15], s64 offen lds
    s_add_u32 s67, s67, 1
    s_cmp_eq_u32 s67, 7
    s_cselect_b32 s67, 0, s67
    s_mul_i32 s64, s67, 172032
    s_add_u32 s64, s64, s96
    s_add_u32 m0, s76, 2048
    s_nop 0
    buffer_load_dwordx4 v10, s[12:15], s64 offen lds
    s_add_u32 s67, s67, 1
    s_cmp_eq_u32 s67, 7
    s_cselect_b32 s67, 0, s67
    s_mul_i32 s64, s67, 172032
    s_add_u32 s64, s64, s96
    s_add_u32 m0, s76, 3072
    s_nop 0
    buffer_load_dwordx4 v10, s[12:15], s64 offen lds
    s_add_u32 s67, s67, 1
    s_cmp_eq_u32 s67, 7
    s_cselect_b32 s67, 0, s67
    s_mul_i32 s64, s67, 172032
    s_add_u32 s64, s64, s96
    s_add_u32 m0, s76, 4096
    s_nop 0
    buffer_load_dwordx4 v10, s[12:15], s64 offen lds
    s_add_u32 s67, s67, 1
    s_cmp_eq_u32 s67, 7
    s_cselect_b32 s67, 0, s67
    s_mul_i32 s64, s67, 172032
    s_add_u32 s64, s64, s96
    s_add_u32 m0, s76, 5120
    s_nop 0
    buffer_load_dwordx4 v10, s[12:15], s64 offen lds
    s_add_u32 s67, s67, 1
    s_cmp_eq_u32 s67, 7
    s_cselect_b32 s67, 0, s67
    s_mul_i32 s64, s67, 172032
    s_add_u32 s64, s64, s96
    s_add_u32 m0, s76, 6144
    s_nop 0
    buffer_load_dwordx4 v10, s[12:15], s64 offen lds
    s_add_u32 s67, s67, 1
    s_cmp_eq_u32 s67, 7
    s_cselect_b32 s67, 0, s67
    s_branch L_g1_t3
L_g1_job:
    v_bfe_u32 v44, v0, 2, 2
    v_lshl_add_u32 v44, v4, 3, v44
    v_mul_u32_u24 v44, 56, v44
    v_bfe_u32 v12, v0, 4, 1
    v_and_b32 v13, 3, v0
    v_lshl_add_u32 v12, v12, 2, v13
    v_min_u32 v12, 6, v12
    v_lshl_add_u32 v44, v12, 3, v44
    v_add_u32 v44, 122880, v44
    s_lshl_b32 s64, s30, 1
    s_add_u32 s64, s64, s26
    s_sub_u32 s64, s64, 1
    s_lshl_b32 s64, s64, 2
    s_add_u32 s64, s64, s25
    s_lshl_b32 s64, s64, 10
    s_add_u32 s68, s64, 524288
    v_mov_b32 v24, 0
    v_mov_b32 v25, 0
    v_mov_b32 v26, 0
    v_mov_b32 v27, 0
    s_lshl_b32 s69, s59, 12
    s_add_u32 s69, s69, 0
    s_lshl_b32 s71, s30, 1
    s_add_u32 s71, s71, s26
    s_lshl_b32 s71, s71, 7
    s_lshl_b32 s61, s25, 3
    s_add_u32 s71, s71, s61
    s_add_u32 s71, s71, 655360
    buffer_store_dwordx4 v[24:27], v2, s[16:19], s68 offen sc1
    s_cmp_eq_u32 s26, 2
    s_cbranch_scc1 L_g1_vjob
    v_and_b32 v46, 0x33, v0
    v_bfe_u32 v23, v0, 2, 1
    v_lshl_add_u32 v46, v23, 3, v46
    v_bfe_u32 v23, v0, 3, 1
    v_lshl_add_u32 v46, v23, 2, v46
    v_lshlrev_b32 v46, 4, v46
    s_mov_b32 s61, 300000
lw_44:
    ds_read_b32 v12, v5 offset:128
    s_waitcnt lgkmcnt(0)
    v_readfirstlane_b32 s60, v12
    s_sub_u32 s61, s61, 1
    s_cbranch_scc1 lwd_45
    s_cmp_ge_u32 s60, 4
    s_cbranch_scc1 lwd_45
    s_branch lw_44
lwd_45:
    ds_read_b128 v[64:67], v40 offset:0
    ds_read_b128 v[68:71], v41 offset:0
    ds_read_b128 v[72:75], v42 offset:0
    ds_read_b128 v[76:79], v43 offset:0
    s_mov_b64 exec, 1
    ds_add_u32 v5, v6 offset:160
    s_mov_b64 exec, -1
    ds_read_b64_tr_b16 v[176:177], v44 offset:0
    ds_read_b64_tr_b16 v[178:179], v44 offset:224
    ds_read_b64_tr_b16 v[180:181], v44 offset:1024
    ds_read_b64_tr_b16 v[182:183], v44 offset:1248
    ds_read_b64_tr_b16 v[184:185], v44 offset:2048
    ds_read_b64_tr_b16 v[186:187], v44 offset:2272
    ds_read_b64_tr_b16 v[188:189], v44 offset:3072
    ds_read_b64_tr_b16 v[190:191], v44 offset:3296
    ds_read_b32 v13, v5 offset:132
    s_waitcnt lgkmcnt(0)
    v_readfirstlane_b32 s60, v13
    v_mfma_f32_32x32x16_bf16 v[240:255], v[176:179], v[64:67], 0
    s_cmp_ge_u32 s60, 4
    s_cbranch_scc0 fslow_46
    ds_read_b128 v[80:83], v40 offset:4096
    ds_read_b128 v[84:87], v41 offset:4096
    ds_read_b128 v[88:91], v42 offset:4096
    ds_read_b128 v[92:95], v43 offset:4096
    s_mov_b64 exec, 1
    ds_add_u32 v5, v6 offset:164
    s_mov_b64 exec, -1
    v_mfma_f32_32x32x16_bf16 v[240:255], v[180:183], v[68:71], v[240:255]
    ds_read_b64_tr_b16 v[208:209], v44 offset:4096
    ds_read_b64_tr_b16 v[210:211], v44 offset:4320
    ds_read_b64_tr_b16 v[212:213], v44 offset:5120
    ds_read_b64_tr_b16 v[214:215], v44 offset:5344
    ds_read_b64_tr_b16 v[216:217], v44 offset:6144
    v_mfma_f32_32x32x16_bf16 v[240:255], v[184:187], v[72:75], v[240:255]
    ds_read_b64_tr_b16 v[218:219], v44 offset:6368
    ds_read_b64_tr_b16 v[220:221], v44 offset:7168
    ds_read_b64_tr_b16 v[222:223], v44 offset:7392
    ds_read_b32 v13, v5 offset:136
    v_mfma_f32_32x32x16_bf16 v[240:255], v[188:191], v[76:79], v[240:255]
fok_47:
    s_waitcnt lgkmcnt(0)
    v_readfirstlane_b32 s60, v13
    v_mfma_f32_32x32x16_bf16 v[240:255], v[208:211], v[80:83], v[240:255]
    s_cmp_ge_u32 s60, 4
    s_cbranch_scc0 fslow_48
    ds_read_b128 v[96:99], v40 offset:8192
    ds_read_b128 v[100:103], v41 offset:8192
    ds_read_b128 v[104:107], v42 offset:8192
    ds_read_b128 v[108:111], v43 offset:8192
    s_mov_b64 exec, 1
    ds_add_u32 v5, v6 offset:168
    s_mov_b64 exec, -1
    v_mfma_f32_32x32x16_bf16 v[240:255], v[212:215], v[84:87], v[240:255]
    ds_read_b64_tr_b16 v[176:177], v44 offset:8192
    ds_read_b64_tr_b16 v[178:179], v44 offset:8416
    ds_read_b64_tr_b16 v[180:181], v44 offset:9216
    ds_read_b64_tr_b16 v[182:183], v44 offset:9440
    ds_read_b64_tr_b16 v[184:185], v44 offset:10240
    v_mfma_f32_32x32x16_bf16 v[240:255], v[216:219], v[88:91], v[240:255]
    ds_read_b64_tr_b16 v[186:187], v44 offset:10464
    ds_read_b64_tr_b16 v[188:189], v44 offset:11264
    ds_read_b64_tr_b16 v[190:191], v44 offset:11488
    ds_read_b32 v13, v5 offset:140
    v_mfma_f32_32x32x16_bf16 v[240:255], v[220:223], v[92:95], v[240:255]
fok_49:
    s_waitcnt lgkmcnt(0)
    v_readfirstlane_b32 s60, v13
    v_mfma_f32_32x32x16_bf16 v[240:255], v[176:179], v[96:99], v[240:255]
    s_cmp_ge_u32 s60, 4
    s_cbranch_scc0 fslow_50
    ds_read_b128 v[112:115], v40 offset:12288
    ds_read_b128 v[116:119], v41 offset:12288
    ds_read_b128 v[120:123], v42 offset:12288
    ds_read_b128 v[124:127], v43 offset:12288
    ds_read_b64_tr_b16 v[208:209], v44 offset:12288
    v_mfma_f32_32x32x16_bf16 v[240:255], v[180:183], v[100:103], v[240:255]
    ds_read_b64_tr_b16 v[210:211], v44 offset:12512
    ds_read_b64_tr_b16 v[212:213], v44 offset:13312
    ds_read_b64_tr_b16 v[214:215], v44 offset:13536
    ds_read_b64_tr_b16 v[216:217], v44 offset:14336
    ds_read_b64_tr_b16 v[218:219], v44 offset:14560
    v_mfma_f32_32x32x16_bf16 v[240:255], v[184:187], v[104:107], v[240:255]
    ds_read_b64_tr_b16 v[220:221], v44 offset:15360
    ds_read_b64_tr_b16 v[222:223], v44 offset:15584
    ds_read_b32 v13, v5 offset:144
    v_mfma_f32_32x32x16_bf16 v[240:255], v[188:191], v[108:111], v[240:255]
fok_51:
    s_waitcnt lgkmcnt(0)
    v_readfirstlane_b32 s60, v13
    v_mfma_f32_32x32x16_bf16 v[240:255], v[208:211], v[112:115], v[240:255]
    s_cmp_ge_u32 s60, 4
    s_cbranch_scc0 fslow_52
    ds_read_b128 v[128:131], v40 offset:0
    ds_read_b128 v[132:135], v41 offset:0
    ds_read_b128 v[136:139], v42 offset:0
    ds_read_b128 v[140:143], v43 offset:0
    ds_read_b64_tr_b16 v[176:177], v44 offset:16384
    v_mfma_f32_32x32x16_bf16 v[240:255], v[212:215], v[116:119], v[240:255]
    ds_read_b64_tr_b16 v[178:179], v44 offset:16608
    ds_read_b64_tr_b16 v[180:181], v44 offset:17408
    ds_read_b64_tr_b16 v[182:183], v44 offset:17632
    ds_read_b64_tr_b16 v[184:185], v44 offset:18432
    ds_read_b64_tr_b16 v[186:187], v44 offset:18656
    v_mfma_f32_32x32x16_bf16 v[240:255], v[216:219], v[120:123], v[240:255]
    ds_read_b64_tr_b16 v[188:189], v44 offset:19456
    ds_read_b64_tr_b16 v[190:191], v44 offset:19680
    ds_read_b32 v13, v5 offset:148
    v_mfma_f32_32x32x16_bf16 v[240:255], v[220:223], v[124:127], v[240:255]
fok_53:
    s_waitcnt lgkmcnt(0)
    v_readfirstlane_b32 s60, v13
    v_mfma_f32_32x32x16_bf16 v[240:255], v[176:179], v[128:131], v[240:255]
    s_cmp_ge_u32 s60, 4
    s_cbranch_scc0 fslow_54
    ds_read_b128 v[144:147], v40 offset:4096
    ds_read_b128 v[148:151], v41 offset:4096
    ds_read_b128 v[152:155], v42 offset:4096
    ds_read_b128 v[156:159], v43 offset:4096
    ds_read_b64_tr_b16 v[208:209], v44 offset:20480
    v_mfma_f32_32x32x16_bf16 v[240:255], v[180:183], v[132:135], v[240:255]
    ds_read_b64_tr_b16 v[210:211], v44 offset:20704
    ds_read_b64_tr_b16 v[212:213], v44 offset:21504
    ds_read_b64_tr_b16 v[214:215], v44 offset:21728
    ds_read_b64_tr_b16 v[216:217], v44 offset:22528
    ds_read_b64_tr_b16 v[218:219], v44 offset:22752
    v_mfma_f32_32x32x16_bf16 v[240:255], v[184:187], v[136:139], v[240:255]
    ds_read_b64_tr_b16 v[220:221], v44 offset:23552
    ds_read_b64_tr_b16 v[222:223], v44 offset:23776
    ds_read_b32 v13, v5 offset:152
    v_mfma_f32_32x32x16_bf16 v[240:255], v[188:191], v[140:143], v[240:255]
fok_55:
    s_waitcnt lgkmcnt(0)
    v_readfirstlane_b32 s60, v13
    v_mfma_f32_32x32x16_bf16 v[240:255], v[208:211], v[144:147], v[240:255]
    s_cmp_ge_u32 s60, 4
    s_cbranch_scc0 fslow_56
    ds_read_b128 v[160:163], v40 offset:8192
    ds_read_b128 v[164:167], v41 offset:8192
    ds_read_b128 v[168:171], v42 offset:8192
    ds_read_b128 v[172:175], v43 offset:8192
    s_mov_b64 exec, 1
    ds_add_u32 v5, v6 offset:172
    s_mov_b64 exec, -1
    v_mfma_f32_32x32x16_bf16 v[240:255], v[212:215], v[148:151], v[240:255]
    ds_read_b64_tr_b16 v[176:177], v44 offset:24576
    ds_read_b64_tr_b16 v[178:179], v44 offset:24800
    ds_read_b64_tr_b16 v[180:181], v44 offset:25600
    ds_read_b64_tr_b16 v[182:183], v44 offset:25824
    ds_read_b64_tr_b16 v[184:185], v44 offset:26624
    v_mfma_f32_32x32x16_bf16 v[240:255], v[216:219], v[152:155], v[240:255]
    ds_read_b64_tr_b16 v[186:187], v44 offset:26848
    ds_read_b64_tr_b16 v[188:189], v44 offset:27648
    ds_read_b64_tr_b16 v[190:191], v44 offset:27872
    v_mfma_f32_32x32x16_bf16 v[240:255], v[220:223], v[156:159], v[240:255]
fok_57:
    s_waitcnt lgkmcnt(0)
    v_mfma_f32_32x32x16_bf16 v[240:255], v[176:179], v[160:163], v[240:255]
    v_mfma_f32_32x32x16_bf16 v[240:255], v[180:183], v[164:167], v[240:255]
    v_mfma_f32_32x32x16_bf16 v[240:255], v[184:187], v[168:171], v[240:255]
    v_mfma_f32_32x32x16_bf16 v[240:255], v[188:191], v[172:175], v[240:255]
    s_nop 11
    v_mul_f32 v240, s70, v240
    v_mul_f32 v241, s70, v241
    v_mul_f32 v242, s70, v242
    v_mul_f32 v243, s70, v243
    v_mul_f32 v244, s70, v244
    v_mul_f32 v245, s70, v245
    v_mul_f32 v246, s70, v246
    v_mul_f32 v247, s70, v247
    v_mul_f32 v248, s70, v248
    v_mul_f32 v249, s70, v249
    v_mul_f32 v250, s70, v250
    v_mul_f32 v251, s70, v251
    v_mul_f32 v252, s70, v252
    v_mul_f32 v253, s70, v253
    v_mul_f32 v254, s70, v254
    v_mul_f32 v255, s70, v255
    v_cvt_pk_bf16_f32 v32, v240, v241
    v_cvt_pk_bf16_f32 v33, v242, v243
    v_cvt_pk_bf16_f32 v34, v244, v245
    v_cvt_pk_bf16_f32 v35, v246, v247
    v_cvt_pk_bf16_f32 v36, v248, v249
    v_cvt_pk_bf16_f32 v37, v250, v251
    v_cvt_pk_bf16_f32 v38, v252, v253
    v_cvt_pk_bf16_f32 v39, v254, v255
    s_mov_b32 exec_lo, 0
    v_mov_b32 v38, 0x3f803f80
    v_mov_b32 v39, 0
    s_mov_b32 exec_lo, -1
    s_branch L_g1_jobend
L_g1_vjob:
    v_mul_u32_u24 v46, 37, v3
    v_lshrrev_b32 v46, 8, v46
    v_mul_u32_u24 v47, 7, v46
    v_sub_u32 v47, v3, v47
    v_cmp_lt_u32 vcc, 27, v3
    s_nop 1
    v_cndmask_b32 v46, v46, v47, vcc
    v_cndmask_b32 v47, v47, 7, vcc
    v_and_b32 v23, 4, v47
    v_add_u32 v47, v47, v23
    v_and_b32 v23, 1, v46
    v_lshl_add_u32 v47, v23, 2, v47
    v_lshrrev_b32 v46, 1, v46
    v_lshl_add_u32 v47, v46, 4, v47
    v_lshl_add_u32 v47, v4, 5, v47
    v_lshlrev_b32 v46, 4, v47
    s_add_u32 s69, s69, 2048
    s_mov_b32 s61, 300000
lw_58:
    ds_read_b32 v12, v5 offset:128
    s_waitcnt lgkmcnt(0)
    v_readfirstlane_b32 s60, v12
    s_sub_u32 s61, s61, 1
    s_cbranch_scc1 lwd_59
    s_cmp_ge_u32 s60, 4
    s_cbranch_scc1 lwd_59
    s_branch lw_58
lwd_59:
    ds_read_b128 v[64:67], v40 offset:0
    ds_read_b128 v[68:71], v41 offset:0
    ds_read_b128 v[72:75], v42 offset:0
    ds_read_b128 v[76:79], v43 offset:0
    s_mov_b64 exec, 1
    ds_add_u32 v5, v6 offset:160
    s_mov_b64 exec, -1
    ds_read_b64_tr_b16 v[176:177], v44 offset:0
    ds_read_b64_tr_b16 v[178:179], v44 offset:224
    ds_read_b64_tr_b16 v[180:181], v44 offset:1024
    ds_read_b64_tr_b16 v[182:183], v44 offset:1248
    ds_read_b64_tr_b16 v[184:185], v44 offset:2048
    ds_read_b64_tr_b16 v[186:187], v44 offset:2272
    ds_read_b64_tr_b16 v[188:189], v44 offset:3072
    ds_read_b64_tr_b16 v[190:191], v44 offset:3296
    ds_read_b32 v13, v5 offset:132
    s_waitcnt lgkmcnt(0)
    v_readfirstlane_b32 s60, v13
    v_mfma_f32_32x32x16_bf16 v[240:255], v[64:67], v[176:179], 0
    s_cmp_ge_u32 s60, 4
    s_cbranch_scc0 fslow_60
    ds_read_b128 v[80:83], v40 offset:4096
    ds_read_b128 v[84:87], v41 offset:4096
    ds_read_b128 v[88:91], v42 offset:4096
    ds_read_b128 v[92:95], v43 offset:4096
    s_mov_b64 exec, 1
    ds_add_u32 v5, v6 offset:164
    s_mov_b64 exec, -1
    v_mfma_f32_32x32x16_bf16 v[240:255], v[68:71], v[180:183], v[240:255]
    ds_read_b64_tr_b16 v[208:209], v44 offset:4096
    ds_read_b64_tr_b16 v[210:211], v44 offset:4320
    ds_read_b64_tr_b16 v[212:213], v44 offset:5120
    ds_read_b64_tr_b16 v[214:215], v44 offset:5344
    ds_read_b64_tr_b16 v[216:217], v44 offset:6144
    v_mfma_f32_32x32x16_bf16 v[240:255], v[72:75], v[184:187], v[240:255]
    ds_read_b64_tr_b16 v[218:219], v44 offset:6368
    ds_read_b64_tr_b16 v[220:221], v44 offset:7168
    ds_read_b64_tr_b16 v[222:223], v44 offset:7392
    ds_read_b32 v13, v5 offset:136
    v_mfma_f32_32x32x16_bf16 v[240:255], v[76:79], v[188:191], v[240:255]
fok_61:
    s_waitcnt lgkmcnt(0)
    v_readfirstlane_b32 s60, v13
    v_mfma_f32_32x32x16_bf16 v[240:255], v[80:83], v[208:211], v[240:255]
    s_cmp_ge_u32 s60, 4
    s_cbranch_scc0 fslow_62
    ds_read_b128 v[96:99], v40 offset:8192
    ds_read_b128 v[100:103], v41 offset:8192
    ds_read_b128 v[104:107], v42 offset:8192
    ds_read_b128 v[108:111], v43 offset:8192
    s_mov_b64 exec, 1
    ds_add_u32 v5, v6 offset:168
    s_mov_b64 exec, -1
    v_mfma_f32_32x32x16_bf16 v[240:255], v[84:87], v[212:215], v[240:255]
    ds_read_b64_tr_b16 v[176:177], v44 offset:8192
    ds_read_b64_tr_b16 v[178:179], v44 offset:8416
    ds_read_b64_tr_b16 v[180:181], v44 offset:9216
    ds_read_b64_tr_b16 v[182:183], v44 offset:9440
    ds_read_b64_tr_b16 v[184:185], v44 offset:10240
    v_mfma_f32_32x32x16_bf16 v[240:255], v[88:91], v[216:219], v[240:255]
    ds_read_b64_tr_b16 v[186:187], v44 offset:10464
    ds_read_b64_tr_b16 v[188:189], v44 offset:11264
    ds_read_b64_tr_b16 v[190:191], v44 offset:11488
    ds_read_b32 v13, v5 offset:140
    v_mfma_f32_32x32x16_bf16 v[240:255], v[92:95], v[220:223], v[240:255]
fok_63:
    s_waitcnt lgkmcnt(0)
    v_readfirstlane_b32 s60, v13
    v_mfma_f32_32x32x16_bf16 v[240:255], v[96:99], v[176:179], v[240:255]
    s_cmp_ge_u32 s60, 4
    s_cbranch_scc0 fslow_64
    ds_read_b128 v[112:115], v40 offset:12288
    ds_read_b128 v[116:119], v41 offset:12288
    ds_read_b128 v[120:123], v42 offset:12288
    ds_read_b128 v[124:127], v43 offset:12288
    ds_read_b64_tr_b16 v[208:209], v44 offset:12288
    v_mfma_f32_32x32x16_bf16 v[240:255], v[100:103], v[180:183], v[240:255]
    ds_read_b64_tr_b16 v[210:211], v44 offset:12512
    ds_read_b64_tr_b16 v[212:213], v44 offset:13312
    ds_read_b64_tr_b16 v[214:215], v44 offset:13536
    ds_read_b64_tr_b16 v[216:217], v44 offset:14336
    ds_read_b64_tr_b16 v[218:219], v44 offset:14560
    v_mfma_f32_32x32x16_bf16 v[240:255], v[104:107], v[184:187], v[240:255]
    ds_read_b64_tr_b16 v[220:221], v44 offset:15360
    ds_read_b64_tr_b16 v[222:223], v44 offset:15584
    ds_read_b32 v13, v5 offset:144
    v_mfma_f32_32x32x16_bf16 v[240:255], v[108:111], v[188:191], v[240:255]
fok_65:
    s_waitcnt lgkmcnt(0)
    v_readfirstlane_b32 s60, v13
    v_mfma_f32_32x32x16_bf16 v[240:255], v[112:115], v[208:211], v[240:255]
    s_cmp_ge_u32 s60, 4
    s_cbranch_scc0 fslow_66
    ds_read_b128 v[128:131], v40 offset:0
    ds_read_b128 v[132:135], v41 offset:0
    ds_read_b128 v[136:139], v42 offset:0
    ds_read_b128 v[140:143], v43 offset:0
    ds_read_b64_tr_b16 v[176:177], v44 offset:16384
    v_mfma_f32_32x32x16_bf16 v[240:255], v[116:119], v[212:215], v[240:255]
    ds_read_b64_tr_b16 v[178:179], v44 offset:16608
    ds_read_b64_tr_b16 v[180:181], v44 offset:17408
    ds_read_b64_tr_b16 v[182:183], v44 offset:17632
    ds_read_b64_tr_b16 v[184:185], v44 offset:18432
    ds_read_b64_tr_b16 v[186:187], v44 offset:18656
    v_mfma_f32_32x32x16_bf16 v[240:255], v[120:123], v[216:219], v[240:255]
    ds_read_b64_tr_b16 v[188:189], v44 offset:19456
    ds_read_b64_tr_b16 v[190:191], v44 offset:19680
    ds_read_b32 v13, v5 offset:148
    v_mfma_f32_32x32x16_bf16 v[240:255], v[124:127], v[220:223], v[240:255]
fok_67:
    s_waitcnt lgkmcnt(0)
    v_readfirstlane_b32 s60, v13
    v_mfma_f32_32x32x16_bf16 v[240:255], v[128:131], v[176:179], v[240:255]
    s_cmp_ge_u32 s60, 4
    s_cbranch_scc0 fslow_68
    ds_read_b128 v[144:147], v40 offset:4096
    ds_read_b128 v[148:151], v41 offset:4096
    ds_read_b128 v[152:155], v42 offset:4096
    ds_read_b128 v[156:159], v43 offset:4096
    ds_read_b64_tr_b16 v[208:209], v44 offset:20480
    v_mfma_f32_32x32x16_bf16 v[240:255], v[132:135], v[180:183], v[240:255]
    ds_read_b64_tr_b16 v[210:211], v44 offset:20704
    ds_read_b64_tr_b16 v[212:213], v44 offset:21504
    ds_read_b64_tr_b16 v[214:215], v44 offset:21728
    ds_read_b64_tr_b16 v[216:217], v44 offset:22528
    ds_read_b64_tr_b16 v[218:219], v44 offset:22752
    v_mfma_f32_32x32x16_bf16 v[240:255], v[136:139], v[184:187], v[240:255]
    ds_read_b64_tr_b16 v[220:221], v44 offset:23552
    ds_read_b64_tr_b16 v[222:223], v44 offset:23776
    ds_read_b32 v13, v5 offset:152
    v_mfma_f32_32x32x16_bf16 v[240:255], v[140:143], v[188:191], v[240:255]
fok_69:
    s_waitcnt lgkmcnt(0)
    v_readfirstlane_b32 s60, v13
    v_mfma_f32_32x32x16_bf16 v[240:255], v[144:147], v[208:211], v[240:255]
    s_cmp_ge_u32 s60, 4
    s_cbranch_scc0 fslow_70
    ds_read_b128 v[160:163], v40 offset:8192
    ds_read_b128 v[164:167], v41 offset:8192
    ds_read_b128 v[168:171], v42 offset:8192
    ds_read_b128 v[172:175], v43 offset:8192
    s_mov_b64 exec, 1
    ds_add_u32 v5, v6 offset:172
    s_mov_b64 exec, -1
    v_mfma_f32_32x32x16_bf16 v[240:255], v[148:151], v[212:215], v[240:255]
    ds_read_b64_tr_b16 v[176:177], v44 offset:24576
    ds_read_b64_tr_b16 v[178:179], v44 offset:24800
    ds_read_b64_tr_b16 v[180:181], v44 offset:25600
    ds_read_b64_tr_b16 v[182:183], v44 offset:25824
    ds_read_b64_tr_b16 v[184:185], v44 offset:26624
    v_mfma_f32_32x32x16_bf16 v[240:255], v[152:155], v[216:219], v[240:255]
    ds_read_b64_tr_b16 v[186:187], v44 offset:26848
    ds_read_b64_tr_b16 v[188:189], v44 offset:27648
    ds_read_b64_tr_b16 v[190:191], v44 offset:27872
    v_mfma_f32_32x32x16_bf16 v[240:255], v[156:159], v[220:223], v[240:255]
fok_71:
    s_waitcnt lgkmcnt(0)
    v_mfma_f32_32x32x16_bf16 v[240:255], v[160:163], v[176:179], v[240:255]
    v_mfma_f32_32x32x16_bf16 v[240:255], v[164:167], v[180:183], v[240:255]
    v_mfma_f32_32x32x16_bf16 v[240:255], v[168:171], v[184:187], v[240:255]
    v_mfma_f32_32x32x16_bf16 v[240:255], v[172:175], v[188:191], v[240:255]
    s_nop 11
    v_cvt_pk_bf16_f32 v32, v240, v241
    v_cvt_pk_bf16_f32 v33, v242, v243
    v_cvt_pk_bf16_f32 v34, v244, v245
    v_cvt_pk_bf16_f32 v35, v246, v247
    v_cvt_pk_bf16_f32 v36, v248, v249
    v_cvt_pk_bf16_f32 v37, v250, v251
    v_cvt_pk_bf16_f32 v38, v252, v253
    v_cvt_pk_bf16_f32 v39, v254, v255
    v_cmp_gt_u32 vcc, 30, v3
    v_mov_b32 v23, 0x3f803f80
    s_mov_b32 s62, 0xf0000000
    s_mov_b32 s63, 0xf0000000
    v_cndmask_b32 v23, 0, v23, vcc
    v_cndmask_b32 v32, v32, v23, s[62:63]
    v_cndmask_b32 v33, v33, v23, s[62:63]
    v_cndmask_b32 v34, v34, v23, s[62:63]
    v_cndmask_b32 v35, v35, v23, s[62:63]
    v_cndmask_b32 v36, v36, v23, s[62:63]
    v_cndmask_b32 v37, v37, v23, s[62:63]
    v_cndmask_b32 v38, v38, v23, s[62:63]
    v_cndmask_b32 v39, v39, v23, s[62:63]
L_g1_jobend:
    buffer_store_dwordx4 v[32:35], v46, s[16:19], s69 offen sc1
    buffer_store_dwordx4 v[36:39], v46, s[16:19], s69 offen offset:1024 sc1
    s_mov_b64 exec, 1
    ds_add_u32 v5, v6 offset:100
    s_mov_b64 exec, -1
    v_mul_f32 v47, v240, v240
    v_mul_f32 v23, v241, v241
    v_fmac_f32 v47, v242, v242
    v_fmac_f32 v23, v243, v243
    v_fmac_f32 v47, v244, v244
    v_fmac_f32 v23, v245, v245
    v_fmac_f32 v47, v246, v246
    v_fmac_f32 v23, v247, v247
    v_fmac_f32 v47, v248, v248
    v_fmac_f32 v23, v249, v249
    v_fmac_f32 v47, v250, v250
    v_fmac_f32 v23, v251, v251
    s_mov_b32 exec_hi, 0
    v_fmac_f32 v47, v252, v252
    v_fmac_f32 v23, v253, v253
    v_fmac_f32 v47, v254, v254
    v_fmac_f32 v23, v255, v255
    s_mov_b32 exec_hi, -1
    v_add_f32 v47, v47, v23
    v_mov_b32 v23, v47
    s_nop 1
    v_permlane32_swap_b32 v47, v23
    v_add_f32 v47, v47, v23
    v_sqrt_f32 v47, v47
    s_nop 1
    v_max_f32_dpp v47, v47, v47 row_shr:1 row_mask:0xf bank_mask:0xf
    s_nop 1
    v_max_f32_dpp v47, v47, v47 row_shr:2 row_mask:0xf bank_mask:0xf
    s_nop 1
    v_max_f32_dpp v47, v47, v47 row_shr:4 row_mask:0xf bank_mask:0xf
    s_nop 1
    v_max_f32_dpp v47, v47, v47 row_shr:8 row_mask:0xf bank_mask:0xf
    s_nop 1
    v_max_f32_dpp v47, v47, v47 row_bcast:15 row_mask:0xa bank_mask:0xf
    s_nop 1
    v_max_f32_dpp v47, v47, v47 row_bcast:31 row_mask:0xc bank_mask:0xf
    s_nop 0
    v_readlane_b32 s60, v47, 63
    s_cmp_eq_u32 s26, 1
    s_cselect_b32 s60, s60, 0
    v_mov_b32 v46, s58
    v_mov_b32 v47, s60
    s_waitcnt vmcnt(0)
    s_mov_b64 exec, 1
    buffer_store_dwordx2 v[46:47], v2, s[16:19], s71 offen sc1
    s_mov_b64 exec, -1
    s_mov_b64 exec, 1
    ds_add_u32 v5, v6 offset:100
    s_mov_b64 exec, -1
    s_mov_b32 s61, 300000
lw_72:
    ds_read_b32 v12, v5 offset:64
    s_waitcnt lgkmcnt(0)
    v_readfirstlane_b32 s60, v12
    s_sub_u32 s61, s61, 1
    s_cbranch_scc1 lwd_73
    s_cmp_ge_u32 s60, 4
    s_cbranch_scc1 lwd_73
    s_branch lw_72
lwd_73:
    ds_read_b64_tr_b16 v[176:177], v17 offset:0
    ds_read_b64_tr_b16 v[178:179], v17 offset:256
    ds_read_b64_tr_b16 v[180:181], v17 offset:1024
    ds_read_b64_tr_b16 v[182:183], v17 offset:1280
    ds_read_b64_tr_b16 v[184:185], v17 offset:2048
    ds_read_b64_tr_b16 v[186:187], v17 offset:2304
    ds_read_b64_tr_b16 v[188:189], v17 offset:3072
    ds_read_b64_tr_b16 v[190:191], v17 offset:3328
    ds_read_b64_tr_b16 v[192:193], v17 offset:4096
    ds_read_b64_tr_b16 v[194:195], v17 offset:4352
    ds_read_b64_tr_b16 v[196:197], v17 offset:5120
    ds_read_b64_tr_b16 v[198:199], v17 offset:5376
    ds_read_b64_tr_b16 v[200:201], v17 offset:6144
    ds_read_b64_tr_b16 v[202:203], v17 offset:6400
    s_waitcnt lgkmcnt(12)
    v_mfma_f32_32x32x16_bf16 v[224:239], v[176:179], v[64:67], 0
    ds_read_b64_tr_b16 v[204:205], v17 offset:7168
    ds_read_b64_tr_b16 v[206:207], v17 offset:7424
    s_waitcnt lgkmcnt(12)
    v_mfma_f32_32x32x16_bf16 v[224:239], v[180:183], v[68:71], v[224:239]
    ds_read_b64_tr_b16 v[208:209], v17 offset:8192
    ds_read_b64_tr_b16 v[210:211], v17 offset:8448
    s_waitcnt lgkmcnt(12)
    v_mfma_f32_32x32x16_bf16 v[224:239], v[184:187], v[72:75], v[224:239]
    ds_read_b64_tr_b16 v[212:213], v17 offset:9216
    ds_read_b64_tr_b16 v[214:215], v17 offset:9472
    s_waitcnt lgkmcnt(12)
    v_mfma_f32_32x32x16_bf16 v[224:239], v[188:191], v[76:79], v[224:239]
    ds_read_b64_tr_b16 v[216:217], v17 offset:10240
    ds_read_b64_tr_b16 v[218:219], v17 offset:10496
    s_waitcnt lgkmcnt(12)
    v_mfma_f32_32x32x16_bf16 v[224:239], v[192:195], v[80:83], v[224:239]
    ds_read_b64_tr_b16 v[220:221], v17 offset:11264
    ds_read_b64_tr_b16 v[222:223], v17 offset:11520
    s_waitcnt lgkmcnt(12)
    v_mfma_f32_32x32x16_bf16 v[224:239], v[196:199], v[84:87], v[224:239]
    ds_read_b64_tr_b16 v[176:177], v17 offset:12288
    ds_read_b64_tr_b16 v[178:179], v17 offset:12544
    s_waitcnt lgkmcnt(12)
    v_mfma_f32_32x32x16_bf16 v[224:239], v[200:203], v[88:91], v[224:239]
    ds_read_b64_tr_b16 v[180:181], v17 offset:13312
    ds_read_b64_tr_b16 v[182:183], v17 offset:13568
    s_waitcnt lgkmcnt(12)
    v_mfma_f32_32x32x16_bf16 v[224:239], v[204:207], v[92:95], v[224:239]
    ds_read_b64_tr_b16 v[184:185], v17 offset:14336
    ds_read_b64_tr_b16 v[186:187], v17 offset:14592
    s_waitcnt lgkmcnt(12)
    v_mfma_f32_32x32x16_bf16 v[224:239], v[208:211], v[96:99], v[224:239]
    ds_read_b64_tr_b16 v[188:189], v17 offset:15360
    ds_read_b64_tr_b16 v[190:191], v17 offset:15616
    s_waitcnt lgkmcnt(12)
    v_mfma_f32_32x32x16_bf16 v[224:239], v[212:215], v[100:103], v[224:239]
    ds_read_b64_tr_b16 v[192:193], v17 offset:16384
    ds_read_b64_tr_b16 v[194:195], v17 offset:16640
    s_waitcnt lgkmcnt(12)
    v_mfma_f32_32x32x16_bf16 v[224:239], v[216:219], v[104:107], v[224:239]
    ds_read_b64_tr_b16 v[196:197], v17 offset:17408
    ds_read_b64_tr_b16 v[198:199], v17 offset:17664
    s_waitcnt lgkmcnt(12)
    v_mfma_f32_32x32x16_bf16 v[224:239], v[220:223], v[108:111], v[224:239]
    ds_read_b64_tr_b16 v[200:201], v17 offset:18432
    ds_read_b64_tr_b16 v[202:203], v17 offset:18688
    s_waitcnt lgkmcnt(12)
    v_mfma_f32_32x32x16_bf16 v[224:239], v[176:179], v[112:115], v[224:239]
    ds_read_b64_tr_b16 v[204:205], v17 offset:19456
    ds_read_b64_tr_b16 v[206:207], v17 offset:19712
    s_waitcnt lgkmcnt(12)
    v_mfma_f32_32x32x16_bf16 v[224:239], v[180:183], v[116:119], v[224:239]
    ds_read_b64_tr_b16 v[208:209], v17 offset:20480
    ds_read_b64_tr_b16 v[210:211], v17 offset:20736
    s_waitcnt lgkmcnt(12)
    v_mfma_f32_32x32x16_bf16 v[224:239], v[184:187], v[120:123], v[224:239]
    ds_read_b64_tr_b16 v[212:213], v17 offset:21504
    ds_read_b64_tr_b16 v[214:215], v17 offset:21760
    s_waitcnt lgkmcnt(12)
    v_mfma_f32_32x32x16_bf16 v[224:239], v[188:191], v[124:127], v[224:239]
    ds_read_b64_tr_b16 v[216:217], v17 offset:22528
    ds_read_b64_tr_b16 v[218:219], v17 offset:22784
    s_waitcnt lgkmcnt(12)
    v_mfma_f32_32x32x16_bf16 v[224:239], v[192:195], v[128:131], v[224:239]
    ds_read_b64_tr_b16 v[220:221], v17 offset:23552
    ds_read_b64_tr_b16 v[222:223], v17 offset:23808
    s_waitcnt lgkmcnt(12)
    v_mfma_f32_32x32x16_bf16 v[224:239], v[196:199], v[132:135], v[224:239]
    ds_read_b64_tr_b16 v[176:177], v17 offset:24576
    ds_read_b64_tr_b16 v[178:179], v17 offset:24832
    s_waitcnt lgkmcnt(12)
    v_mfma_f32_32x32x16_bf16 v[224:239], v[200:203], v[136:139], v[224:239]
    ds_read_b64_tr_b16 v[180:181], v17 offset:25600
    ds_read_b64_tr_b16 v[182:183], v17 offset:25856
    s_waitcnt lgkmcnt(12)
    v_mfma_f32_32x32x16_bf16 v[224:239], v[204:207], v[140:143], v[224:239]
    ds_read_b64_tr_b16 v[184:185], v17 offset:26624
    ds_read_b64_tr_b16 v[186:187], v17 offset:26880
    s_waitcnt lgkmcnt(12)
    v_mfma_f32_32x32x16_bf16 v[224:239], v[208:211], v[144:147], v[224:239]
    ds_read_b64_tr_b16 v[188:189], v17 offset:27648
    ds_read_b64_tr_b16 v[190:191], v17 offset:27904
    s_waitcnt lgkmcnt(12)
    v_mfma_f32_32x32x16_bf16 v[224:239], v[212:215], v[148:151], v[224:239]
    s_waitcnt lgkmcnt(10)
    v_mfma_f32_32x32x16_bf16 v[224:239], v[216:219], v[152:155], v[224:239]
    s_waitcnt lgkmcnt(8)
    v_mfma_f32_32x32x16_bf16 v[224:239], v[220:223], v[156:159], v[224:239]
    s_waitcnt lgkmcnt(6)
    v_mfma_f32_32x32x16_bf16 v[224:239], v[176:179], v[160:163], v[224:239]
    s_waitcnt lgkmcnt(4)
    v_mfma_f32_32x32x16_bf16 v[224:239], v[180:183], v[164:167], v[224:239]
    s_waitcnt lgkmcnt(2)
    v_mfma_f32_32x32x16_bf16 v[224:239], v[184:187], v[168:171], v[224:239]
    s_waitcnt lgkmcnt(0)
    v_mfma_f32_32x32x16_bf16 v[224:239], v[188:191], v[172:175], v[224:239]
    s_nop 11
    v_cvt_pk_bf16_f32 v32, v224, v225
    v_cvt_pk_bf16_f32 v33, v226, v227
    v_cvt_pk_bf16_f32 v34, v228, v229
    v_cvt_pk_bf16_f32 v35, v230, v231
    v_cvt_pk_bf16_f32 v36, v232, v233
    v_cvt_pk_bf16_f32 v37, v234, v235
    v_cvt_pk_bf16_f32 v38, v236, v237
    v_cvt_pk_bf16_f32 v39, v238, v239
    ds_write_b128 v20, v[32:35] offset:12288
    ds_write_b128 v20, v[36:39] offset:13312
    ds_write_b32 v22, v6 offset:176
    s_mov_b32 s61, 300000
lw_74:
    ds_read_b32 v12, v5 offset:68
    s_waitcnt lgkmcnt(0)
    v_readfirstlane_b32 s60, v12
    s_sub_u32 s61, s61, 1
    s_cbranch_scc1 lwd_75
    s_cmp_ge_u32 s60, 4
    s_cbranch_scc1 lwd_75
    s_branch lw_74
lwd_75:
    ds_read_b64_tr_b16 v[176:177], v17 offset:28672
    ds_read_b64_tr_b16 v[178:179], v17 offset:28928
    ds_read_b64_tr_b16 v[180:181], v17 offset:29696
    ds_read_b64_tr_b16 v[182:183], v17 offset:29952
    ds_read_b64_tr_b16 v[184:185], v17 offset:30720
    ds_read_b64_tr_b16 v[186:187], v17 offset:30976
    ds_read_b64_tr_b16 v[188:189], v17 offset:31744
    ds_read_b64_tr_b16 v[190:191], v17 offset:32000
    ds_read_b64_tr_b16 v[192:193], v17 offset:32768
    ds_read_b64_tr_b16 v[194:195], v17 offset:33024
    ds_read_b64_tr_b16 v[196:197], v17 offset:33792
    ds_read_b64_tr_b16 v[198:199], v17 offset:34048
    ds_read_b64_tr_b16 v[200:201], v17 offset:34816
    ds_read_b64_tr_b16 v[202:203], v17 offset:35072
    s_waitcnt lgkmcnt(12)
    v_mfma_f32_32x32x16_bf16 v[240:255], v[176:179], v[64:67], 0
    ds_read_b64_tr_b16 v[204:205], v17 offset:35840
    ds_read_b64_tr_b16 v[206:207], v17 offset:36096
    s_waitcnt lgkmcnt(12)
    v_mfma_f32_32x32x16_bf16 v[240:255], v[180:183], v[68:71], v[240:255]
    ds_read_b64_tr_b16 v[208:209], v17 offset:36864
    ds_read_b64_tr_b16 v[210:211], v17 offset:37120
    s_waitcnt lgkmcnt(12)
    v_mfma_f32_32x32x16_bf16 v[240:255], v[184:187], v[72:75], v[240:255]
    ds_read_b64_tr_b16 v[212:213], v17 offset:37888
    ds_read_b64_tr_b16 v[214:215], v17 offset:38144
    s_waitcnt lgkmcnt(12)
    v_mfma_f32_32x32x16_bf16 v[240:255], v[188:191], v[76:79], v[240:255]
    ds_read_b64_tr_b16 v[216:217], v17 offset:38912
    ds_read_b64_tr_b16 v[218:219], v17 offset:39168
    s_waitcnt lgkmcnt(12)
    v_mfma_f32_32x32x16_bf16 v[240:255], v[192:195], v[80:83], v[240:255]
    ds_read_b64_tr_b16 v[220:221], v17 offset:39936
    ds_read_b64_tr_b16 v[222:223], v17 offset:40192
    s_waitcnt lgkmcnt(12)
    v_mfma_f32_32x32x16_bf16 v[240:255], v[196:199], v[84:87], v[240:255]
    ds_read_b64_tr_b16 v[176:177], v17 offset:40960
    ds_read_b64_tr_b16 v[178:179], v17 offset:41216
    s_waitcnt lgkmcnt(12)
    v_mfma_f32_32x32x16_bf16 v[240:255], v[200:203], v[88:91], v[240:255]
    ds_read_b64_tr_b16 v[180:181], v17 offset:41984
    ds_read_b64_tr_b16 v[182:183], v17 offset:42240
    s_waitcnt lgkmcnt(12)
    v_mfma_f32_32x32x16_bf16 v[240:255], v[204:207], v[92:95], v[240:255]
    ds_read_b64_tr_b16 v[184:185], v17 offset:43008
    ds_read_b64_tr_b16 v[186:187], v17 offset:43264
    s_waitcnt lgkmcnt(12)
    v_mfma_f32_32x32x16_bf16 v[240:255], v[208:211], v[96:99], v[240:255]
    ds_read_b64_tr_b16 v[188:189], v17 offset:44032
    ds_read_b64_tr_b16 v[190:191], v17 offset:44288
    s_waitcnt lgkmcnt(12)
    v_mfma_f32_32x32x16_bf16 v[240:255], v[212:215], v[100:103], v[240:255]
    ds_read_b64_tr_b16 v[192:193], v17 offset:45056
    ds_read_b64_tr_b16 v[194:195], v17 offset:45312
    s_waitcnt lgkmcnt(12)
    v_mfma_f32_32x32x16_bf16 v[240:255], v[216:219], v[104:107], v[240:255]
    ds_read_b64_tr_b16 v[196:197], v17 offset:46080
    ds_read_b64_tr_b16 v[198:199], v17 offset:46336
    s_waitcnt lgkmcnt(12)
    v_mfma_f32_32x32x16_bf16 v[240:255], v[220:223], v[108:111], v[240:255]
    ds_read_b64_tr_b16 v[200:201], v17 offset:47104
    ds_read_b64_tr_b16 v[202:203], v17 offset:47360
    s_waitcnt lgkmcnt(12)
    v_mfma_f32_32x32x16_bf16 v[240:255], v[176:179], v[112:115], v[240:255]
    ds_read_b64_tr_b16 v[204:205], v17 offset:48128
    ds_read_b64_tr_b16 v[206:207], v17 offset:48384
    s_waitcnt lgkmcnt(12)
    v_mfma_f32_32x32x16_bf16 v[240:255], v[180:183], v[116:119], v[240:255]
    ds_read_b64_tr_b16 v[208:209], v17 offset:49152
    ds_read_b64_tr_b16 v[210:211], v17 offset:49408
    s_waitcnt lgkmcnt(12)
    v_mfma_f32_32x32x16_bf16 v[240:255], v[184:187], v[120:123], v[240:255]
    ds_read_b64_tr_b16 v[212:213], v17 offset:50176
    ds_read_b64_tr_b16 v[214:215], v17 offset:50432
    s_waitcnt lgkmcnt(12)
    v_mfma_f32_32x32x16_bf16 v[240:255], v[188:191], v[124:127], v[240:255]
    ds_read_b64_tr_b16 v[216:217], v17 offset:51200
    ds_read_b64_tr_b16 v[218:219], v17 offset:51456
    s_waitcnt lgkmcnt(12)
    v_mfma_f32_32x32x16_bf16 v[240:255], v[192:195], v[128:131], v[240:255]
    ds_read_b64_tr_b16 v[220:221], v17 offset:52224
    ds_read_b64_tr_b16 v[222:223], v17 offset:52480
    s_waitcnt lgkmcnt(12)
    v_mfma_f32_32x32x16_bf16 v[240:255], v[196:199], v[132:135], v[240:255]
    ds_read_b64_tr_b16 v[176:177], v17 offset:53248
    ds_read_b64_tr_b16 v[178:179], v17 offset:53504
    s_waitcnt lgkmcnt(12)
    v_mfma_f32_32x32x16_bf16 v[240:255], v[200:203], v[136:139], v[240:255]
    ds_read_b64_tr_b16 v[180:181], v17 offset:54272
    ds_read_b64_tr_b16 v[182:183], v17 offset:54528
    s_waitcnt lgkmcnt(12)
    v_mfma_f32_32x32x16_bf16 v[240:255], v[204:207], v[140:143], v[240:255]
    ds_read_b64_tr_b16 v[184:185], v17 offset:55296
    ds_read_b64_tr_b16 v[186:187], v17 offset:55552
    s_waitcnt lgkmcnt(12)
    v_mfma_f32_32x32x16_bf16 v[240:255], v[208:211], v[144:147], v[240:255]
    ds_read_b64_tr_b16 v[188:189], v17 offset:56320
    ds_read_b64_tr_b16 v[190:191], v17 offset:56576
    s_waitcnt lgkmcnt(12)
    v_mfma_f32_32x32x16_bf16 v[240:255], v[212:215], v[148:151], v[240:255]
    s_waitcnt lgkmcnt(10)
    v_mfma_f32_32x32x16_bf16 v[240:255], v[216:219], v[152:155], v[240:255]
    s_waitcnt lgkmcnt(8)
    v_mfma_f32_32x32x16_bf16 v[240:255], v[220:223], v[156:159], v[240:255]
    s_waitcnt lgkmcnt(6)
    v_mfma_f32_32x32x16_bf16 v[240:255], v[176:179], v[160:163], v[240:255]
    s_waitcnt lgkmcnt(4)
    v_mfma_f32_32x32x16_bf16 v[240:255], v[180:183], v[164:167], v[240:255]
    s_waitcnt lgkmcnt(2)
    v_mfma_f32_32x32x16_bf16 v[240:255], v[184:187], v[168:171], v[240:255]
    s_waitcnt lgkmcnt(0)
    v_mfma_f32_32x32x16_bf16 v[240:255], v[188:191], v[172:175], v[240:255]
    s_nop 11
    v_mul_f32 v18, 0xbfb8aa3b, v252
    v_exp_f32 v18, v18
    v_mul_f32 v14, v240, v240
    v_mul_f32 v23, v241, v241
    v_fmac_f32 v14, v242, v242
    v_fmac_f32 v23, v243, v243
    v_fmac_f32 v14, v244, v244
    v_fmac_f32 v23, v245, v245
    v_fmac_f32 v14, v246, v246
    v_fmac_f32 v23, v247, v247
    v_fmac_f32 v14, v248, v248
    v_fmac_f32 v23, v249, v249
    v_fmac_f32 v14, v250, v250
    v_fmac_f32 v23, v251, v251
    s_mov_b32 exec_hi, 0
    v_fmac_f32 v14, v252, v252
    v_fmac_f32 v23, v253, v253
    v_fmac_f32 v14, v254, v254
    v_fmac_f32 v23, v255, v255
    s_mov_b32 exec_hi, -1
    v_add_f32 v14, v14, v23
    v_mov_b32 v23, v14
    s_nop 1
    v_permlane32_swap_b32 v14, v23
    v_add_f32 v14, v14, v23
    v_sqrt_f32 v14, v14
    v_add_f32 v18, 1.0, v18
    v_rcp_f32 v18, v18
    v_cvt_pk_bf16_f32 v24, v240, v241
    v_cvt_pk_bf16_f32 v25, v242, v243
    v_cvt_pk_bf16_f32 v26, v244, v245
    v_cvt_pk_bf16_f32 v27, v246, v247
    v_cvt_pk_bf16_f32 v28, v248, v249
    v_cvt_pk_bf16_f32 v29, v250, v251
    v_cvt_pk_bf16_f32 v30, v252, v253
    v_cvt_pk_bf16_f32 v31, v254, v255
    v_mov_b32 v23, v18
    s_mov_b32 exec_lo, 0
    v_mov_b32 v31, v14
    s_mov_b32 exec_lo, -1
    v_permlane32_swap_b32 v23, v18
    ds_write_b128 v20, v[24:27] offset:14336
    ds_write_b128 v20, v[28:31] offset:15360
    ds_write_b32 v16, v18
    s_mov_b64 exec, 1
    ds_add_u32 v5, v6 offset:4
    s_mov_b64 exec, -1
    s_mul_i32 s64, s67, 172032
    s_add_u32 s64, s64, s96
    s_add_u32 m0, s76, 0
    s_nop 0
    buffer_load_dwordx4 v10, s[12:15], s64 offen lds
    s_add_u32 s67, s67, 1
    s_cmp_eq_u32 s67, 7
    s_cselect_b32 s67, 0, s67
    s_mul_i32 s64, s67, 172032
    s_add_u32 s64, s64, s96
    s_add_u32 m0, s76, 1024
    s_nop 0
    buffer_load_dwordx4 v10, s[12:15], s64 offen lds
    s_add_u32 s67, s67, 1
    s_cmp_eq_u32 s67, 7
    s_cselect_b32 s67, 0, s67
    s_mul_i32 s64, s67, 172032
    s_add_u32 s64, s64, s96
    s_add_u32 m0, s76, 2048
    s_nop 0
    buffer_load_dwordx4 v10, s[12:15], s64 offen lds
    s_add_u32 s67, s67, 1
    s_cmp_eq_u32 s67, 7
    s_cselect_b32 s67, 0, s67
    s_mul_i32 s64, s67, 172032
    s_add_u32 s64, s64, s96
    s_add_u32 m0, s76, 3072
    s_nop 0
    buffer_load_dwordx4 v10, s[12:15], s64 offen lds
    s_add_u32 s67, s67, 1
    s_cmp_eq_u32 s67, 7
    s_cselect_b32 s67, 0, s67
    s_mul_i32 s64, s67, 172032
    s_add_u32 s64, s64, s96
    s_add_u32 m0, s76, 4096
    s_nop 0
    buffer_load_dwordx4 v10, s[12:15], s64 offen lds
    s_add_u32 s67, s67, 1
    s_cmp_eq_u32 s67, 7
    s_cselect_b32 s67, 0, s67
    s_mul_i32 s64, s67, 172032
    s_add_u32 s64, s64, s96
    s_add_u32 m0, s76, 5120
    s_nop 0
    buffer_load_dwordx4 v10, s[12:15], s64 offen lds
    s_add_u32 s67, s67, 1
    s_cmp_eq_u32 s67, 7
    s_cselect_b32 s67, 0, s67
    s_mul_i32 s64, s67, 172032
    s_add_u32 s64, s64, s96
    s_add_u32 m0, s76, 6144
    s_nop 0
    buffer_load_dwordx4 v10, s[12:15], s64 offen lds
    s_add_u32 s67, s67, 1
    s_cmp_eq_u32 s67, 7
    s_cselect_b32 s67, 0, s67
L_g1_t3:
    s_setprio 0
    s_mov_b32 s61, 300000
lw_76:
    ds_read_b32 v12, v5 offset:72
    s_waitcnt lgkmcnt(0)
    v_readfirstlane_b32 s60, v12
    s_sub_u32 s61, s61, 1
    s_cbranch_scc1 lwd_77
    s_cmp_ge_u32 s60, 4
    s_cbranch_scc1 lwd_77
    s_branch lw_76
lwd_77:
    ds_read_b64_tr_b16 v[176:177], v11 offset:0
    ds_read_b64_tr_b16 v[178:179], v11 offset:256
    ds_read_b64_tr_b16 v[180:181], v11 offset:1024
    ds_read_b64_tr_b16 v[182:183], v11 offset:1280
    ds_read_b64_tr_b16 v[184:185], v11 offset:2048
    ds_read_b64_tr_b16 v[186:187], v11 offset:2304
    ds_read_b64_tr_b16 v[188:189], v11 offset:3072
    ds_read_b64_tr_b16 v[190:191], v11 offset:3328
    ds_read_b64_tr_b16 v[192:193], v11 offset:4096
    ds_read_b64_tr_b16 v[194:195], v11 offset:4352
    ds_read_b64_tr_b16 v[196:197], v11 offset:5120
    ds_read_b64_tr_b16 v[198:199], v11 offset:5376
    ds_read_b64_tr_b16 v[200:201], v11 offset:6144
    ds_read_b64_tr_b16 v[202:203], v11 offset:6400
    s_waitcnt lgkmcnt(12)
    v_mfma_f32_32x32x16_bf16 v[224:239], v[64:67], v[176:179], 0
    ds_read_b64_tr_b16 v[204:205], v11 offset:7168
    ds_read_b64_tr_b16 v[206:207], v11 offset:7424
    s_waitcnt lgkmcnt(12)
    v_mfma_f32_32x32x16_bf16 v[224:239], v[68:71], v[180:183], v[224:239]
    ds_read_b64_tr_b16 v[208:209], v11 offset:8192
    ds_read_b64_tr_b16 v[210:211], v11 offset:8448
    s_waitcnt lgkmcnt(12)
    v_mfma_f32_32x32x16_bf16 v[224:239], v[72:75], v[184:187], v[224:239]
    ds_read_b64_tr_b16 v[212:213], v11 offset:9216
    ds_read_b64_tr_b16 v[214:215], v11 offset:9472
    s_waitcnt lgkmcnt(12)
    v_mfma_f32_32x32x16_bf16 v[224:239], v[76:79], v[188:191], v[224:239]
    ds_read_b64_tr_b16 v[216:217], v11 offset:10240
    ds_read_b64_tr_b16 v[218:219], v11 offset:10496
    s_waitcnt lgkmcnt(12)
    v_mfma_f32_32x32x16_bf16 v[224:239], v[80:83], v[192:195], v[224:239]
    ds_read_b64_tr_b16 v[220:221], v11 offset:11264
    ds_read_b64_tr_b16 v[222:223], v11 offset:11520
    s_waitcnt lgkmcnt(12)
    v_mfma_f32_32x32x16_bf16 v[224:239], v[84:87], v[196:199], v[224:239]
    ds_read_b64_tr_b16 v[176:177], v11 offset:12288
    ds_read_b64_tr_b16 v[178:179], v11 offset:12544
    s_waitcnt lgkmcnt(12)
    v_mfma_f32_32x32x16_bf16 v[224:239], v[88:91], v[200:203], v[224:239]
    ds_read_b64_tr_b16 v[180:181], v11 offset:13312
    ds_read_b64_tr_b16 v[182:183], v11 offset:13568
    s_waitcnt lgkmcnt(12)
    v_mfma_f32_32x32x16_bf16 v[224:239], v[92:95], v[204:207], v[224:239]
    ds_read_b64_tr_b16 v[184:185], v11 offset:14336
    ds_read_b64_tr_b16 v[186:187], v11 offset:14592
    s_waitcnt lgkmcnt(12)
    v_mfma_f32_32x32x16_bf16 v[224:239], v[96:99], v[208:211], v[224:239]
    ds_read_b64_tr_b16 v[188:189], v11 offset:15360
    ds_read_b64_tr_b16 v[190:191], v11 offset:15616
    s_waitcnt lgkmcnt(12)
    v_mfma_f32_32x32x16_bf16 v[224:239], v[100:103], v[212:215], v[224:239]
    ds_read_b64_tr_b16 v[192:193], v11 offset:16384
    ds_read_b64_tr_b16 v[194:195], v11 offset:16640
    s_waitcnt lgkmcnt(12)
    v_mfma_f32_32x32x16_bf16 v[224:239], v[104:107], v[216:219], v[224:239]
    ds_read_b64_tr_b16 v[196:197], v11 offset:17408
    ds_read_b64_tr_b16 v[198:199], v11 offset:17664
    s_waitcnt lgkmcnt(12)
    v_mfma_f32_32x32x16_bf16 v[224:239], v[108:111], v[220:223], v[224:239]
    ds_read_b64_tr_b16 v[200:201], v11 offset:18432
    ds_read_b64_tr_b16 v[202:203], v11 offset:18688
    s_waitcnt lgkmcnt(12)
    v_mfma_f32_32x32x16_bf16 v[224:239], v[112:115], v[176:179], v[224:239]
    s_waitcnt vmcnt(0)
    s_mov_b64 exec, 1
    ds_add_u32 v5, v6 offset:76
    s_mov_b64 exec, -1
    ds_read_b64_tr_b16 v[204:205], v11 offset:19456
    ds_read_b64_tr_b16 v[206:207], v11 offset:19712
    s_waitcnt lgkmcnt(13)
    v_mfma_f32_32x32x16_bf16 v[224:239], v[116:119], v[180:183], v[224:239]
    ds_read_b64_tr_b16 v[208:209], v11 offset:20480
    ds_read_b64_tr_b16 v[210:211], v11 offset:20736
    s_waitcnt lgkmcnt(13)
    v_mfma_f32_32x32x16_bf16 v[224:239], v[120:123], v[184:187], v[224:239]
    ds_read_b64_tr_b16 v[212:213], v11 offset:21504
    ds_read_b64_tr_b16 v[214:215], v11 offset:21760
    s_waitcnt lgkmcnt(13)
    v_mfma_f32_32x32x16_bf16 v[224:239], v[124:127], v[188:191], v[224:239]
    ds_read_b64_tr_b16 v[216:217], v11 offset:22528
    ds_read_b64_tr_b16 v[218:219], v11 offset:22784
    s_waitcnt lgkmcnt(13)
    v_mfma_f32_32x32x16_bf16 v[224:239], v[128:131], v[192:195], v[224:239]
    ds_read_b64_tr_b16 v[220:221], v11 offset:23552
    ds_read_b64_tr_b16 v[222:223], v11 offset:23808
    s_waitcnt lgkmcnt(13)
    v_mfma_f32_32x32x16_bf16 v[224:239], v[132:135], v[196:199], v[224:239]
    ds_read_b64_tr_b16 v[176:177], v11 offset:24576
    ds_read_b64_tr_b16 v[178:179], v11 offset:24832
    s_waitcnt lgkmcnt(13)
    v_mfma_f32_32x32x16_bf16 v[224:239], v[136:139], v[200:203], v[224:239]
    ds_read_b64_tr_b16 v[180:181], v11 offset:25600
    ds_read_b64_tr_b16 v[182:183], v11 offset:25856
    s_waitcnt lgkmcnt(12)
    v_mfma_f32_32x32x16_bf16 v[224:239], v[140:143], v[204:207], v[224:239]
    ds_read_b64_tr_b16 v[184:185], v11 offset:26624
    ds_read_b64_tr_b16 v[186:187], v11 offset:26880
    s_waitcnt lgkmcnt(12)
    v_mfma_f32_32x32x16_bf16 v[224:239], v[144:147], v[208:211], v[224:239]
    s_setprio 1
    ds_read_b64_tr_b16 v[188:189], v11 offset:27648
    ds_read_b64_tr_b16 v[190:191], v11 offset:27904
    s_waitcnt lgkmcnt(12)
    v_mfma_f32_32x32x16_bf16 v[224:239], v[148:151], v[212:215], v[224:239]
    s_waitcnt lgkmcnt(10)
    v_mfma_f32_32x32x16_bf16 v[224:239], v[152:155], v[216:219], v[224:239]
    s_waitcnt lgkmcnt(8)
    v_mfma_f32_32x32x16_bf16 v[224:239], v[156:159], v[220:223], v[224:239]
    s_waitcnt lgkmcnt(6)
    v_mfma_f32_32x32x16_bf16 v[224:239], v[160:163], v[176:179], v[224:239]
    s_waitcnt lgkmcnt(4)
    v_mfma_f32_32x32x16_bf16 v[224:239], v[164:167], v[180:183], v[224:239]
    s_waitcnt lgkmcnt(2)
    v_mfma_f32_32x32x16_bf16 v[224:239], v[168:171], v[184:187], v[224:239]
    s_waitcnt lgkmcnt(0)
    v_mfma_f32_32x32x16_bf16 v[224:239], v[172:175], v[188:191], v[224:239]
    s_mov_b64 exec, 1
    ds_add_u32 v5, v6 offset:8
    s_mov_b64 exec, -1
    s_nop 8
    v_cvt_pk_bf16_f32 v32, v224, v225
    v_cvt_pk_bf16_f32 v33, v226, v227
    v_cvt_pk_bf16_f32 v34, v228, v229
    v_cvt_pk_bf16_f32 v35, v230, v231
    v_cvt_pk_bf16_f32 v36, v232, v233
    v_cvt_pk_bf16_f32 v37, v234, v235
    v_cvt_pk_bf16_f32 v38, v236, v237
    v_cvt_pk_bf16_f32 v39, v238, v239
    v_cmp_gt_u32 vcc, 29, v3
    v_mov_b32 v23, 0x3f803f80
    s_mov_b32 s62, 0xf0000000
    s_mov_b32 s63, 0xf0000000
    v_cndmask_b32 v23, 0, v23, vcc
    v_cndmask_b32 v32, v32, v23, s[62:63]
    v_cndmask_b32 v33, v33, v23, s[62:63]
    v_cndmask_b32 v34, v34, v23, s[62:63]
    v_cndmask_b32 v35, v35, v23, s[62:63]
    v_cndmask_b32 v36, v36, v23, s[62:63]
    v_cndmask_b32 v37, v37, v23, s[62:63]
    v_cndmask_b32 v38, v38, v23, s[62:63]
    v_cndmask_b32 v39, v39, v23, s[62:63]
    v_bfe_u32 v22, v0, 2, 2
    v_lshl_add_u32 v22, v4, 2, v22
    v_lshlrev_b32 v22, 6, v22
    v_add_u32 v22, v22, v7
    v_add_u32 v22, 153600, v22
    ds_read_b64_tr_b16 v[24:25], v22 offset:0
    ds_read_b64_tr_b16 v[26:27], v22 offset:512
    ds_read_b64_tr_b16 v[28:29], v22 offset:1024
    ds_read_b64_tr_b16 v[30:31], v22 offset:1536
    v_bfe_u32 v14, v0, 2, 2
    v_lshl_add_u32 v14, v4, 2, v14
    v_mul_u32_u24 v14, 80, v14
    v_and_b32 v13, 1, v0
    v_lshl_add_u32 v14, v13, 5, v14
    v_bfe_u32 v13, v0, 1, 1
    v_lshl_add_u32 v14, v13, 3, v14
    v_and_b32 v13, 16, v0
    v_add_u32 v14, v14, v13
    s_mul_i32 s64, s25, 5120
    s_add_u32 s64, s64, 65536
    v_add_u32 v14, s64, v14
    s_mov_b32 s61, 300000
lw_78:
    ds_read_b32 v12, v5 offset:0
    s_waitcnt lgkmcnt(0)
    v_readfirstlane_b32 s60, v12
    s_sub_u32 s61, s61, 1
    s_cbranch_scc1 lwd_79
    s_cmp_ge_u32 s60, 4
    s_cbranch_scc1 lwd_79
    s_sleep 1
    s_branch lw_78
lwd_79:
    s_setprio 1
    ds_read_b64_tr_b16 v[48:49], v14 offset:0
    ds_read_b64_tr_b16 v[50:51], v14 offset:640
    ds_read_b64_tr_b16 v[52:53], v14 offset:1280
    ds_read_b64_tr_b16 v[54:55], v14 offset:1920
    ds_read_b64_tr_b16 v[56:57], v14 offset:2560
    ds_read_b64_tr_b16 v[58:59], v14 offset:3200
    ds_read_b64_tr_b16 v[60:61], v14 offset:3840
    ds_read_b64_tr_b16 v[62:63], v14 offset:4480
    s_mov_b32 exec_lo, 0
    v_mov_b32 v30, 0
    v_mov_b32 v31, 0
    s_mov_b32 exec_lo, -1
    s_lshl_b32 s64, s25, 13
    s_add_u32 s64, s64, 86016
    v_add_u32 v13, s64, v2
    s_waitcnt lgkmcnt(0)
    v_mfma_f32_32x32x16_bf16 v[176:191], v[48:51], v[32:35], 0
    v_mfma_f32_32x32x16_bf16 v[176:191], v[52:55], v[36:39], v[176:191]
    v_mfma_f32_32x32x16_bf16 v[192:207], v[56:59], v[32:35], 0
    v_mfma_f32_32x32x16_bf16 v[192:207], v[60:63], v[36:39], v[192:207]
    s_lshl_b32 s64, s25, 11
    s_add_u32 s65, s64, 86016
    v_add_u32 v22, s65, v2
    s_lshl_b32 s65, s31, 13
    s_add_u32 s64, s64, s65
    s_add_u32 s64, s64, 524288
    v_lshlrev_b32 v14, 2, v0
    s_lshl_b32 s69, s79, 7
    s_lshl_b32 s61, s25, 2
    s_add_u32 s69, s69, s61
    s_add_u32 s69, s69, 688256
    v_mov_b32 v23, s58
    ds_write_b128 v13, v[176:179] offset:0
    ds_write_b128 v13, v[180:183] offset:1024
    ds_write_b128 v13, v[184:187] offset:2048
    ds_write_b128 v13, v[188:191] offset:3072
    ds_write_b128 v13, v[192:195] offset:4096
    ds_write_b128 v13, v[196:199] offset:5120
    ds_write_b128 v13, v[200:203] offset:6144
    ds_write_b128 v13, v[204:207] offset:7168
    s_mov_b64 exec, 1
    ds_add_u32 v5, v6 offset:0
    s_mov_b64 exec, -1
    s_mov_b32 s61, 300000
lw_80:
    ds_read_b32 v12, v5 offset:0
    s_waitcnt lgkmcnt(0)
    v_readfirstlane_b32 s60, v12
    s_sub_u32 s61, s61, 1
    s_cbranch_scc1 lwd_81
    s_cmp_ge_u32 s60, 8
    s_cbranch_scc1 lwd_81
    s_branch lw_80
lwd_81:
    ds_read_b128 v[176:179], v22 offset:0
    ds_read_b128 v[180:183], v22 offset:1024
    ds_read_b128 v[184:187], v22 offset:8192
    ds_read_b128 v[188:191], v22 offset:9216
    ds_read_b128 v[192:195], v22 offset:16384
    ds_read_b128 v[196:199], v22 offset:17408
    ds_read_b128 v[200:203], v22 offset:24576
    ds_read_b128 v[204:207], v22 offset:25600
    s_waitcnt lgkmcnt(0)
    v_add_f32 v176, v176, v184
    v_add_f32 v192, v192, v200
    v_add_f32 v177, v177, v185
    v_add_f32 v193, v193, v201
    v_add_f32 v178, v178, v186
    v_add_f32 v194, v194, v202
    v_add_f32 v179, v179, v187
    v_add_f32 v195, v195, v203
    v_add_f32 v180, v180, v188
    v_add_f32 v196, v196, v204
    v_add_f32 v181, v181, v189
    v_add_f32 v197, v197, v205
    v_add_f32 v182, v182, v190
    v_add_f32 v198, v198, v206
    v_add_f32 v183, v183, v191
    v_add_f32 v199, v199, v207
    v_add_f32 v32, v176, v192
    v_add_f32 v33, v177, v193
    v_add_f32 v34, v178, v194
    v_add_f32 v35, v179, v195
    v_add_f32 v36, v180, v196
    v_add_f32 v37, v181, v197
    v_add_f32 v38, v182, v198
    v_add_f32 v39, v183, v199
    buffer_atomic_add_f32 v32, v14, s[16:19], s64 offen offset:0
    buffer_atomic_add_f32 v33, v14, s[16:19], s64 offen offset:256
    buffer_atomic_add_f32 v34, v14, s[16:19], s64 offen offset:512
    buffer_atomic_add_f32 v35, v14, s[16:19], s64 offen offset:768
    buffer_atomic_add_f32 v36, v14, s[16:19], s64 offen offset:1024
    buffer_atomic_add_f32 v37, v14, s[16:19], s64 offen offset:1280
    buffer_atomic_add_f32 v38, v14, s[16:19], s64 offen offset:1536
    buffer_atomic_add_f32 v39, v14, s[16:19], s64 offen offset:1792
    s_cmp_eq_u32 s26, 0
    s_cbranch_scc1 L_njq
    s_setprio 0
L_njq:
    s_mov_b32 s61, 300000
lw_82:
    ds_read_b32 v12, v5 offset:76
    s_waitcnt lgkmcnt(0)
    v_readfirstlane_b32 s60, v12
    s_sub_u32 s61, s61, 1
    s_cbranch_scc1 lwd_83
    s_cmp_ge_u32 s60, 4
    s_cbranch_scc1 lwd_83
    s_branch lw_82
lwd_83:
    ds_read_b64_tr_b16 v[176:177], v21 offset:0
    ds_read_b64_tr_b16 v[178:179], v21 offset:256
    ds_read_b64_tr_b16 v[180:181], v21 offset:16384
    ds_read_b64_tr_b16 v[182:183], v21 offset:16640
    ds_read_b64_tr_b16 v[184:185], v21 offset:32768
    ds_read_b64_tr_b16 v[186:187], v21 offset:33024
    ds_read_b64_tr_b16 v[188:189], v21 offset:49152
    ds_read_b64_tr_b16 v[190:191], v21 offset:49408
    ds_read_b64_tr_b16 v[192:193], v21 offset:1024
    ds_read_b64_tr_b16 v[194:195], v21 offset:1280
    ds_read_b64_tr_b16 v[196:197], v21 offset:17408
    ds_read_b64_tr_b16 v[198:199], v21 offset:17664
    ds_read_b64_tr_b16 v[200:201], v21 offset:33792
    ds_read_b64_tr_b16 v[202:203], v21 offset:34048
    s_waitcnt lgkmcnt(12)
    v_mfma_f32_32x32x16_bf16 v[240:255], v[176:179], v[64:67], 0
    ds_read_b64_tr_b16 v[204:205], v21 offset:50176
    ds_read_b64_tr_b16 v[206:207], v21 offset:50432
    s_waitcnt lgkmcnt(12)
    v_mfma_f32_32x32x16_bf16 v[240:255], v[180:183], v[68:71], v[240:255]
    ds_read_b64_tr_b16 v[208:209], v21 offset:2048
    ds_read_b64_tr_b16 v[210:211], v21 offset:2304
    s_waitcnt lgkmcnt(12)
    v_mfma_f32_32x32x16_bf16 v[240:255], v[184:187], v[72:75], v[240:255]
    ds_read_b64_tr_b16 v[212:213], v21 offset:18432
    ds_read_b64_tr_b16 v[214:215], v21 offset:18688
    s_waitcnt lgkmcnt(12)
    v_mfma_f32_32x32x16_bf16 v[240:255], v[188:191], v[76:79], v[240:255]
    ds_read_b64_tr_b16 v[216:217], v21 offset:34816
    ds_read_b64_tr_b16 v[218:219], v21 offset:35072
    s_waitcnt lgkmcnt(12)
    v_mfma_f32_32x32x16_bf16 v[240:255], v[192:195], v[80:83], v[240:255]
    ds_read_b64_tr_b16 v[220:221], v21 offset:51200
    ds_read_b64_tr_b16 v[222:223], v21 offset:51456
    s_waitcnt lgkmcnt(12)
    v_mfma_f32_32x32x16_bf16 v[240:255], v[196:199], v[84:87], v[240:255]
    ds_read_b64_tr_b16 v[176:177], v21 offset:3072
    ds_read_b64_tr_b16 v[178:179], v21 offset:3328
    s_waitcnt lgkmcnt(12)
    v_mfma_f32_32x32x16_bf16 v[240:255], v[200:203], v[88:91], v[240:255]
    ds_read_b64_tr_b16 v[180:181], v21 offset:19456
    ds_read_b64_tr_b16 v[182:183], v21 offset:19712
    s_waitcnt lgkmcnt(12)
    v_mfma_f32_32x32x16_bf16 v[240:255], v[204:207], v[92:95], v[240:255]
    ds_read_b64_tr_b16 v[184:185], v21 offset:35840
    ds_read_b64_tr_b16 v[186:187], v21 offset:36096
    s_waitcnt lgkmcnt(12)
    v_mfma_f32_32x32x16_bf16 v[240:255], v[208:211], v[96:99], v[240:255]
    ds_read_b64_tr_b16 v[188:189], v21 offset:52224
    ds_read_b64_tr_b16 v[190:191], v21 offset:52480
    s_waitcnt lgkmcnt(12)
    v_mfma_f32_32x32x16_bf16 v[240:255], v[212:215], v[100:103], v[240:255]
    ds_read_b64_tr_b16 v[192:193], v21 offset:4096
    ds_read_b64_tr_b16 v[194:195], v21 offset:4352
    s_waitcnt lgkmcnt(12)
    v_mfma_f32_32x32x16_bf16 v[240:255], v[216:219], v[104:107], v[240:255]
    s_waitcnt vmcnt(0)
    s_mov_b64 exec, 1
    buffer_store_dword v23, v2, s[16:19], s69 offen sc1
    s_mov_b64 exec, -1
    ds_read_b64_tr_b16 v[196:197], v21 offset:20480
    ds_read_b64_tr_b16 v[198:199], v21 offset:20736
    s_waitcnt lgkmcnt(12)
    v_mfma_f32_32x32x16_bf16 v[240:255], v[220:223], v[108:111], v[240:255]
    ds_read_b64_tr_b16 v[200:201], v21 offset:36864
    ds_read_b64_tr_b16 v[202:203], v21 offset:37120
    s_waitcnt lgkmcnt(12)
    v_mfma_f32_32x32x16_bf16 v[240:255], v[176:179], v[112:115], v[240:255]
    ds_read_b64_tr_b16 v[204:205], v21 offset:53248
    ds_read_b64_tr_b16 v[206:207], v21 offset:53504
    s_waitcnt lgkmcnt(12)
    v_mfma_f32_32x32x16_bf16 v[240:255], v[180:183], v[116:119], v[240:255]
    ds_read_b64_tr_b16 v[208:209], v21 offset:5120
    ds_read_b64_tr_b16 v[210:211], v21 offset:5376
    s_waitcnt lgkmcnt(12)
    v_mfma_f32_32x32x16_bf16 v[240:255], v[184:187], v[120:123], v[240:255]
    ds_read_b64_tr_b16 v[212:213], v21 offset:21504
    ds_read_b64_tr_b16 v[214:215], v21 offset:21760
    s_waitcnt lgkmcnt(12)
    v_mfma_f32_32x32x16_bf16 v[240:255], v[188:191], v[124:127], v[240:255]
    ds_read_b64_tr_b16 v[216:217], v21 offset:37888
    ds_read_b64_tr_b16 v[218:219], v21 offset:38144
    s_waitcnt lgkmcnt(12)
    v_mfma_f32_32x32x16_bf16 v[240:255], v[192:195], v[128:131], v[240:255]
    ds_read_b64_tr_b16 v[220:221], v21 offset:54272
    ds_read_b64_tr_b16 v[222:223], v21 offset:54528
    s_waitcnt lgkmcnt(12)
    v_mfma_f32_32x32x16_bf16 v[240:255], v[196:199], v[132:135], v[240:255]
    ds_read_b64_tr_b16 v[176:177], v21 offset:6144
    ds_read_b64_tr_b16 v[178:179], v21 offset:6400
    s_waitcnt lgkmcnt(12)
    v_mfma_f32_32x32x16_bf16 v[240:255], v[200:203], v[136:139], v[240:255]
    ds_read_b64_tr_b16 v[180:181], v21 offset:22528
    ds_read_b64_tr_b16 v[182:183], v21 offset:22784
    s_waitcnt lgkmcnt(12)
    v_mfma_f32_32x32x16_bf16 v[240:255], v[204:207], v[140:143], v[240:255]
    ds_read_b64_tr_b16 v[184:185], v21 offset:38912
    ds_read_b64_tr_b16 v[186:187], v21 offset:39168
    s_waitcnt lgkmcnt(12)
    v_mfma_f32_32x32x16_bf16 v[240:255], v[208:211], v[144:147], v[240:255]
    ds_read_b64_tr_b16 v[188:189], v21 offset:55296
    ds_read_b64_tr_b16 v[190:191], v21 offset:55552
    s_waitcnt lgkmcnt(12)
    v_mfma_f32_32x32x16_bf16 v[240:255], v[212:215], v[148:151], v[240:255]
    s_waitcnt lgkmcnt(10)
    v_mfma_f32_32x32x16_bf16 v[240:255], v[216:219], v[152:155], v[240:255]
    s_waitcnt lgkmcnt(8)
    v_mfma_f32_32x32x16_bf16 v[240:255], v[220:223], v[156:159], v[240:255]
    s_waitcnt lgkmcnt(6)
    v_mfma_f32_32x32x16_bf16 v[240:255], v[176:179], v[160:163], v[240:255]
    s_waitcnt lgkmcnt(4)
    v_mfma_f32_32x32x16_bf16 v[240:255], v[180:183], v[164:167], v[240:255]
    s_waitcnt lgkmcnt(2)
    v_mfma_f32_32x32x16_bf16 v[240:255], v[184:187], v[168:171], v[240:255]
    s_waitcnt lgkmcnt(0)
    v_mfma_f32_32x32x16_bf16 v[240:255], v[188:191], v[172:175], v[240:255]
    s_mov_b64 exec, 1
    ds_add_u32 v5, v6 offset:8
    s_mov_b64 exec, -1
    s_nop 8
    v_cvt_pk_bf16_f32 v40, v240, v241
    v_cvt_pk_bf16_f32 v41, v242, v243
    v_cvt_pk_bf16_f32 v42, v244, v245
    v_cvt_pk_bf16_f32 v43, v246, v247
    v_cvt_pk_bf16_f32 v44, v248, v249
    v_cvt_pk_bf16_f32 v45, v250, v251
    v_cvt_pk_bf16_f32 v46, v252, v253
    v_cvt_pk_bf16_f32 v47, v254, v255
    v_mfma_f32_32x32x16_bf16 v[112:127], v[24:27], v[40:43], 0
    s_nop 0
    v_mfma_f32_32x32x16_bf16 v[112:127], v[28:31], v[44:47], v[112:127]
    s_setprio 1
    s_cmp_lg_u32 s26, 0
    s_cbranch_scc1 L_nwt
    s_cmp_eq_u32 s28, 0
    s_cselect_b32 s84, s38, s48
    s_cselect_b32 s85, s39, s49
    s_mov_b32 s86, 401408
    s_mov_b32 s87, 0x00020000
    s_lshr_b32 s60, s27, 3
    s_lshl_b32 s60, s60, 1
    s_add_u32 s60, s60, s29
    s_mul_i32 s60, s60, 50176
    s_lshl_b32 s61, s92, 7
    s_add_u32 s60, s60, s61
    v_mul_u32_u24 v12, 896, v0
    s_mov_b32 exec_hi, 0x00ffffff
    buffer_load_dword v7, v12, s[84:87], s60 offen
    s_mov_b32 exec_hi, -1
L_nwt:
    s_lshl_b32 s60, s94, 7
    v_lshl_add_u32 v17, v0, 11, s60
    s_lshl_b32 s66, s94, 13
    s_lshl_b32 s65, s25, 11
    s_add_u32 s66, s66, s65
    s_add_u32 s66, s66, 524288
    v_lshlrev_b32 v14, 2, v0
    s_add_u32 s65, s77, 156672
    v_add_u32 v40, s65, v2
    v_add_u32 v41, 156672, v2
    s_lshl_b32 s65, s59, 4
    s_add_u32 s67, s65, s95
    s_lshl_b32 s67, s67, 11
    s_add_u32 s67, s67, 3145728
    s_add_u32 s68, s65, s94
    s_lshl_b32 s68, s68, 11
    s_add_u32 s68, s68, 1048576
    v_mov_b32 v76, 0
    v_mov_b32 v77, 0
    v_mov_b32 v78, 0
    v_mov_b32 v79, 0
    s_mov_b32 s70, s93
    s_mov_b32 s71, s92
    v_lshrrev_b32 v10, 16, v8
    v_and_b32 v11, 0xffff, v8
    v_xor_b32 v8, 64, v9
    s_mul_i32 s72, s25, 100352
    s_lshl_b32 s73, s71, 7
    s_add_u32 s72, s72, s73
    s_mul_i32 s73, s25, 14336
    s_lshl_b32 s74, s30, 2
    s_lshl_b32 s60, s70, 1
    s_add_u32 s74, s74, s60
    s_mov_b32 s8, s48
    s_mov_b32 s9, s49
    s_mov_b32 s10, 401408
    s_mov_b32 s11, 0x00020000
    s_mov_b32 s12, s38
    s_mov_b32 s13, s39
    s_mov_b32 s14, 401408
    s_mov_b32 s15, 0x00020000
    v_max3_f32 v20, v112, v113, v114
    v_min3_f32 v21, v112, v113, v114
    v_max3_f32 v20, v20, v115, v116
    v_min3_f32 v21, v21, v115, v116
    v_max3_f32 v20, v20, v117, v118
    v_min3_f32 v21, v21, v117, v118
    v_max3_f32 v20, v20, v119, v120
    v_min3_f32 v21, v21, v119, v120
    v_max3_f32 v20, v20, v121, v122
    v_min3_f32 v21, v21, v121, v122
    v_max3_f32 v20, v20, v123, v124
    v_min3_f32 v21, v21, v123, v124
    v_max3_f32 v20, v20, v125, v126
    v_min3_f32 v21, v21, v125, v126
    v_max_f32 v20, v20, v127
    v_min_f32 v21, v21, v127
    v_mov_b32 v22, v20
    v_mov_b32 v23, v21
    s_nop 0
    v_permlane32_swap_b32 v20, v22
    v_permlane32_swap_b32 v21, v23
    v_max_f32 v20, v20, v22
    v_min_f32 v21, v21, v23
    v_mul_f32 v20, s80, v20
    v_mul_f32 v21, s80, v21
    v_fma_f32 v80, v112, s80, -v20
    v_fma_f32 v96, -v112, s80, v21
    v_fma_f32 v81, v113, s80, -v20
    v_fma_f32 v97, -v113, s80, v21
    v_fma_f32 v82, v114, s80, -v20
    v_fma_f32 v98, -v114, s80, v21
    v_fma_f32 v83, v115, s80, -v20
    v_fma_f32 v99, -v115, s80, v21
    v_fma_f32 v84, v116, s80, -v20
    v_fma_f32 v100, -v116, s80, v21
    v_fma_f32 v85, v117, s80, -v20
    v_fma_f32 v101, -v117, s80, v21
    v_fma_f32 v86, v118, s80, -v20
    v_fma_f32 v102, -v118, s80, v21
    v_fma_f32 v87, v119, s80, -v20
    v_fma_f32 v103, -v119, s80, v21
    v_fma_f32 v88, v120, s80, -v20
    v_fma_f32 v104, -v120, s80, v21
    v_fma_f32 v89, v121, s80, -v20
    v_fma_f32 v105, -v121, s80, v21
    v_fma_f32 v90, v122, s80, -v20
    v_fma_f32 v106, -v122, s80, v21
    v_fma_f32 v91, v123, s80, -v20
    v_fma_f32 v107, -v123, s80, v21
    v_fma_f32 v92, v124, s80, -v20
    v_fma_f32 v108, -v124, s80, v21
    v_fma_f32 v93, v125, s80, -v20
    v_fma_f32 v109, -v125, s80, v21
    v_fma_f32 v94, v126, s80, -v20
    v_fma_f32 v110, -v126, s80, v21
    v_fma_f32 v95, v127, s80, -v20
    v_fma_f32 v111, -v127, s80, v21
    s_setprio 1
    s_mov_b32 s61, 300000
lw_84:
    ds_read_b32 v12, v5 offset:8
    s_waitcnt lgkmcnt(0)
    v_readfirstlane_b32 s60, v12
    s_sub_u32 s61, s61, 1
    s_cbranch_scc1 lwd_85
    s_cmp_ge_u32 s60, 8
    s_cbranch_scc1 lwd_85
    s_sleep 1
    s_branch lw_84
lwd_85:
    s_mov_b32 s61, 300000
lw_86:
    ds_read_b32 v12, v5 offset:12
    s_waitcnt lgkmcnt(0)
    v_readfirstlane_b32 s60, v12
    s_sub_u32 s61, s61, 1
    s_cbranch_scc1 lwd_87
    s_cmp_ge_u32 s60, 4
    s_cbranch_scc1 lwd_87
    s_sleep 1
    s_branch lw_86
lwd_87:
    s_setprio 0
    s_cmp_lg_u32 s26, 0
    s_cbranch_scc1 nojob_88
    s_add_u32 m0, s73, 58368
    s_add_u32 s62, s72, 0
    buffer_load_dwordx4 v10, s[8:11], s62 offen lds
    s_add_u32 m0, s73, 59392
    s_add_u32 s62, s72, 7168
    buffer_load_dwordx4 v10, s[8:11], s62 offen lds
    s_add_u32 m0, s73, 60416
    s_add_u32 s62, s72, 14336
    buffer_load_dwordx4 v10, s[8:11], s62 offen lds
    s_add_u32 m0, s73, 61440
    s_add_u32 s62, s72, 21504
    buffer_load_dwordx4 v10, s[8:11], s62 offen lds
    s_waitcnt vmcnt(6)
    s_add_u32 m0, s73, 62464
    s_add_u32 s62, s72, 28672
    buffer_load_dwordx4 v10, s[8:11], s62 offen lds
    s_add_u32 m0, s73, 63488
    s_add_u32 s62, s72, 35840
    buffer_load_dwordx4 v10, s[8:11], s62 offen lds
    s_add_u32 m0, s73, 64512
    s_add_u32 s62, s72, 43008
    buffer_load_dwordx4 v10, s[8:11], s62 offen lds
    s_add_u32 m0, s73, 65536
    s_add_u32 s62, s72, 50176
    buffer_load_dwordx4 v10, s[8:11], s62 offen lds
    s_waitcnt vmcnt(6)
    s_add_u32 m0, s73, 66560
    s_add_u32 s62, s72, 57344
    buffer_load_dwordx4 v10, s[8:11], s62 offen lds
    s_add_u32 m0, s73, 67584
    s_add_u32 s62, s72, 64512
    buffer_load_dwordx4 v10, s[8:11], s62 offen lds
    s_add_u32 m0, s73, 68608
    s_add_u32 s62, s72, 71680
    buffer_load_dwordx4 v10, s[8:11], s62 offen lds
    s_add_u32 m0, s73, 69632
    s_add_u32 s62, s72, 78848
    buffer_load_dwordx4 v10, s[8:11], s62 offen lds
    s_waitcnt vmcnt(6)
    s_add_u32 m0, s73, 70656
    s_add_u32 s62, s72, 86016
    buffer_load_dwordx4 v10, s[8:11], s62 offen lds
    s_add_u32 m0, s73, 71680
    s_add_u32 s62, s72, 93184
    buffer_load_dwordx4 v10, s[8:11], s62 offen lds
    s_waitcnt vmcnt(6)
    s_add_u32 m0, s73, 72704
    s_add_u32 s62, s72, 100352
    s_cmp_lg_u32 s25, 3
    s_cbranch_scc1 nojob_88
    buffer_load_dwordx4 v10, s[8:11], s62 offen lds
nojob_88:
    s_setprio 1
    s_cmp_lg_u32 s25, 0
    s_cbranch_scc1 np_89
    s_mov_b32 s60, 688256
    s_mov_b32 s61, 60000
    s_mov_b64 exec, 0xffff
poll_90:
    buffer_load_dwordx4 v[44:47], v17, s[16:19], s60 offen sc1
    s_waitcnt vmcnt(0)
    v_xor_b32 v44, s58, v44
    v_xor_b32 v45, s58, v45
    v_xor_b32 v46, s58, v46
    v_xor_b32 v47, s58, v47
    v_or3_b32 v44, v44, v46, v47
    v_or_b32 v44, v44, v45
    v_cmp_ne_u32 vcc, 0, v44
    s_sub_u32 s61, s61, 1
    s_cselect_b64 vcc, 0, vcc
    s_cmp_eq_u64 vcc, 0
    s_cbranch_scc1 pdone_91
    s_sleep 4
    s_branch poll_90
pdone_91:
    s_mov_b64 exec, -1
    s_mov_b64 exec, 1
    ds_add_u32 v5, v6 offset:92
    s_mov_b64 exec, -1
    s_waitcnt lgkmcnt(0)
    s_wakeup
np_89:
    s_mov_b32 s61, 300000
lw_92:
    ds_read_b32 v12, v5 offset:92
    s_waitcnt lgkmcnt(0)
    v_readfirstlane_b32 s60, v12
    s_sub_u32 s61, s61, 1
    s_cbranch_scc1 lwd_93
    s_cmp_ge_u32 s60, 1
    s_cbranch_scc1 lwd_93
    s_sleep 8
    s_branch lw_92
lwd_93:
    buffer_load_dword v64, v14, s[16:19], s66 offen offset:0 sc1
    buffer_load_dword v65, v14, s[16:19], s66 offen offset:256 sc1
    buffer_load_dword v66, v14, s[16:19], s66 offen offset:512 sc1
    buffer_load_dword v67, v14, s[16:19], s66 offen offset:768 sc1
    buffer_load_dword v68, v14, s[16:19], s66 offen offset:1024 sc1
    buffer_load_dword v69, v14, s[16:19], s66 offen offset:1280 sc1
    buffer_load_dword v70, v14, s[16:19], s66 offen offset:1536 sc1
    buffer_load_dword v71, v14, s[16:19], s66 offen offset:1792 sc1
    buffer_store_dwordx4 v[76:79], v2, s[16:19], s67 offen sc1
    buffer_store_dwordx4 v[76:79], v2, s[16:19], s67 offen offset:1024 sc1
    v_exp_f32 v80, v80
    v_exp_f32 v96, v96
    v_exp_f32 v81, v81
    v_exp_f32 v97, v97
    v_exp_f32 v82, v82
    v_exp_f32 v98, v98
    v_exp_f32 v83, v83
    v_exp_f32 v99, v99
    v_exp_f32 v84, v84
    v_exp_f32 v100, v100
    v_exp_f32 v85, v85
    v_exp_f32 v101, v101
    v_exp_f32 v86, v86
    v_exp_f32 v102, v102
    v_exp_f32 v87, v87
    v_exp_f32 v103, v103
    v_exp_f32 v88, v88
    v_exp_f32 v104, v104
    v_exp_f32 v89, v89
    v_exp_f32 v105, v105
    v_exp_f32 v90, v90
    v_exp_f32 v106, v106
    v_exp_f32 v91, v91
    v_exp_f32 v107, v107
    v_exp_f32 v92, v92
    v_exp_f32 v108, v108
    v_exp_f32 v93, v93
    v_exp_f32 v109, v109
    v_exp_f32 v94, v94
    v_exp_f32 v110, v110
    v_exp_f32 v95, v95
    v_exp_f32 v111, v111
    v_cvt_pk_bf16_f32 v48, v80, v81
    v_cvt_pk_bf16_f32 v56, v96, v97
    v_cvt_pk_bf16_f32 v49, v82, v83
    v_cvt_pk_bf16_f32 v57, v98, v99
    v_cvt_pk_bf16_f32 v50, v84, v85
    v_cvt_pk_bf16_f32 v58, v100, v101
    v_cvt_pk_bf16_f32 v51, v86, v87
    v_cvt_pk_bf16_f32 v59, v102, v103
    v_cvt_pk_bf16_f32 v52, v88, v89
    v_cvt_pk_bf16_f32 v60, v104, v105
    v_cvt_pk_bf16_f32 v53, v90, v91
    v_cvt_pk_bf16_f32 v61, v106, v107
    v_cvt_pk_bf16_f32 v54, v92, v93
    v_cvt_pk_bf16_f32 v62, v108, v109
    v_cvt_pk_bf16_f32 v55, v94, v95
    v_cvt_pk_bf16_f32 v63, v110, v111
    s_setprio 1
    s_waitcnt vmcnt(2)
    v_cvt_pk_bf16_f32 v72, v64, v65
    v_cvt_pk_bf16_f32 v73, v66, v67
    v_cvt_pk_bf16_f32 v74, v68, v69
    v_cvt_pk_bf16_f32 v75, v70, v71
    s_mov_b32 exec_lo, 0x20000000
    s_mov_b32 exec_hi, 0x20000000
    v_mov_b32 v72, 0x3f803f80
    v_mov_b32 v73, 0x3f803f80
    v_mov_b32 v74, 0x3f803f80
    v_mov_b32 v75, 0x3f803f80
    s_mov_b64 exec, -1
    ds_write_b128 v40, v[72:75]
    s_mov_b64 exec, 1
    ds_add_u32 v5, v6 offset:88
    s_mov_b64 exec, -1
    s_setprio 1
    s_mov_b32 s61, 300000
lw_94:
    ds_read_b32 v12, v5 offset:88
    s_waitcnt lgkmcnt(0)
    v_readfirstlane_b32 s60, v12
    s_sub_u32 s61, s61, 1
    s_cbranch_scc1 lwd_95
    s_cmp_ge_u32 s60, 4
    s_cbranch_scc1 lwd_95
    s_sleep 1
    s_branch lw_94
lwd_95:
    ds_read_b128 v[24:27], v41 offset:0
    ds_read_b128 v[28:31], v41 offset:1024
    ds_read_b128 v[32:35], v41 offset:2048
    ds_read_b128 v[36:39], v41 offset:3072
    s_mov_b32 exec_lo, 0
    v_mov_b32 v54, 0
    v_mov_b32 v55, 0
    v_mov_b32 v62, 0
    v_mov_b32 v63, 0
    s_mov_b32 exec_lo, -1
    s_waitcnt lgkmcnt(0)
    v_mfma_f32_32x32x16_bf16 v[112:127], v[24:27], v[48:51], 0
    v_mfma_f32_32x32x16_bf16 v[112:127], v[28:31], v[52:55], v[112:127]
    v_mfma_f32_32x32x16_bf16 v[96:111], v[32:35], v[56:59], 0
    v_mfma_f32_32x32x16_bf16 v[96:111], v[36:39], v[60:63], v[96:111]
    s_nop 9
    v_rcp_f32 v20, v125
    s_nop 0
    v_rcp_f32 v21, v109
    v_mov_b32 v22, 0x358637bd
    v_fma_f32 v22, v20, v124, v22
    v_fma_f32 v22, v21, v108, v22
    v_rcp_f32 v22, v22
    s_nop 0
    v_mul_f32 v22, v22, v18
    v_mul_f32 v20, v20, v22
    v_mul_f32 v21, v21, v22
    v_mov_b32 v12, v20
    v_mov_b32 v13, v21
    s_nop 0
    v_permlane32_swap_b32 v12, v20
    v_permlane32_swap_b32 v13, v21
    v_mul_f32 v112, v112, v20
    v_mul_f32 v113, v113, v20
    v_mul_f32 v114, v114, v20
    v_mul_f32 v115, v115, v20
    v_mul_f32 v116, v116, v20
    v_mul_f32 v117, v117, v20
    v_mul_f32 v118, v118, v20
    v_mul_f32 v119, v119, v20
    v_mul_f32 v120, v120, v20
    v_mul_f32 v121, v121, v20
    v_mul_f32 v122, v122, v20
    v_mul_f32 v123, v123, v20
    v_mul_f32 v124, v124, v20
    v_mul_f32 v125, v125, v20
    v_mul_f32 v126, v126, v20
    v_mul_f32 v127, v127, v20
    v_fmac_f32 v112, v96, v21
    v_fmac_f32 v113, v97, v21
    v_fmac_f32 v114, v98, v21
    v_fmac_f32 v115, v99, v21
    v_fmac_f32 v116, v100, v21
    v_fmac_f32 v117, v101, v21
    v_fmac_f32 v118, v102, v21
    v_fmac_f32 v119, v103, v21
    v_fmac_f32 v120, v104, v21
    v_fmac_f32 v121, v105, v21
    v_fmac_f32 v122, v106, v21
    v_fmac_f32 v123, v107, v21
    v_fmac_f32 v124, v108, v21
    v_fmac_f32 v125, v109, v21
    v_fmac_f32 v126, v110, v21
    v_fmac_f32 v127, v111, v21
    v_cvt_pk_bf16_f32 v64, v112, v113
    v_cvt_pk_bf16_f32 v65, v114, v115
    v_cvt_pk_bf16_f32 v66, v116, v117
    v_cvt_pk_bf16_f32 v67, v118, v119
    v_cvt_pk_bf16_f32 v68, v120, v121
    v_cvt_pk_bf16_f32 v69, v122, v123
    v_cvt_pk_bf16_f32 v70, v124, v125
    v_cvt_pk_bf16_f32 v71, v126, v127
    s_mov_b32 exec_lo, 0
    v_mov_b32 v70, 0
    v_mov_b32 v71, 0
    s_mov_b32 exec_lo, -1
    buffer_store_dwordx4 v[64:67], v2, s[16:19], s68 offen sc1
    buffer_store_dwordx4 v[68:71], v2, s[16:19], s68 offen offset:1024 sc1
    s_lshl_b32 s60, s79, 7
    s_lshl_b32 s61, s25, 2
    s_add_u32 s60, s60, s61
    s_add_u32 s60, s60, 721024
    s_waitcnt vmcnt(0)
    v_mov_b32 v12, 0
    v_mov_b32 v13, s58
    s_mov_b64 exec, 1
    buffer_store_dword v13, v12, s[16:19], s60 offen sc1
    s_mov_b64 exec, -1
    s_cmp_eq_u32 s26, 0
    s_cbranch_scc1 L_g1_op
    s_mov_b64 exec, 1
    ds_add_u32 v5, v6 offset:24
    s_mov_b64 exec, -1
    s_mov_b64 exec, 1
    ds_add_u32 v5, v6 offset:24
    s_mov_b64 exec, -1
    s_branch L_tag
L_g1_op:
    s_mov_b64 exec, 1
    ds_add_u32 v5, v6 offset:24
    s_mov_b64 exec, -1
    s_setprio 0
    ds_read_b64_tr_b16 v[128:129], v9 offset:0
    ds_read_b64_tr_b16 v[130:131], v9 offset:512
    ds_read_b64_tr_b16 v[132:133], v8 offset:1792
    ds_read_b64_tr_b16 v[134:135], v8 offset:2304
    ds_read_b64_tr_b16 v[136:137], v9 offset:3584
    ds_read_b64_tr_b16 v[138:139], v9 offset:4096
    ds_read_b64_tr_b16 v[140:141], v8 offset:5376
    ds_read_b64_tr_b16 v[142:143], v8 offset:5888
    ds_read_b64_tr_b16 v[144:145], v9 offset:7168
    ds_read_b64_tr_b16 v[146:147], v9 offset:7680
    ds_read_b64_tr_b16 v[148:149], v8 offset:8960
    ds_read_b64_tr_b16 v[150:151], v8 offset:9472
    s_waitcnt lgkmcnt(10)
    ds_read_b64_tr_b16 v[152:153], v9 offset:10752
    ds_read_b64_tr_b16 v[154:155], v9 offset:11264
    s_waitcnt lgkmcnt(10)
    ds_read_b64_tr_b16 v[156:157], v8 offset:12544
    ds_read_b64_tr_b16 v[158:159], v8 offset:13056
    s_waitcnt lgkmcnt(10)
    ds_read_b64_tr_b16 v[160:161], v9 offset:14336
    ds_read_b64_tr_b16 v[162:163], v9 offset:14848
    s_waitcnt lgkmcnt(10)
    ds_read_b64_tr_b16 v[164:165], v8 offset:16128
    ds_read_b64_tr_b16 v[166:167], v8 offset:16640
    s_waitcnt lgkmcnt(10)
    ds_read_b64_tr_b16 v[168:169], v9 offset:17920
    ds_read_b64_tr_b16 v[170:171], v9 offset:18432
    s_waitcnt lgkmcnt(10)
    ds_read_b64_tr_b16 v[172:173], v8 offset:19712
    ds_read_b64_tr_b16 v[174:175], v8 offset:20224
    s_waitcnt lgkmcnt(10)
    ds_read_b64_tr_b16 v[176:177], v9 offset:21504
    ds_read_b64_tr_b16 v[178:179], v9 offset:22016
    s_waitcnt lgkmcnt(10)
    ds_read_b64_tr_b16 v[180:181], v8 offset:23296
    ds_read_b64_tr_b16 v[182:183], v8 offset:23808
    s_waitcnt lgkmcnt(10)
    ds_read_b64_tr_b16 v[184:185], v9 offset:25088
    ds_read_b64_tr_b16 v[186:187], v9 offset:25600
    s_waitcnt lgkmcnt(10)
    ds_read_b64_tr_b16 v[188:189], v8 offset:26880
    ds_read_b64_tr_b16 v[190:191], v8 offset:27392
    s_waitcnt lgkmcnt(10)
    ds_read_b64_tr_b16 v[192:193], v9 offset:28672
    ds_read_b64_tr_b16 v[194:195], v9 offset:29184
    s_waitcnt lgkmcnt(10)
    ds_read_b64_tr_b16 v[196:197], v8 offset:30464
    ds_read_b64_tr_b16 v[198:199], v8 offset:30976
    s_waitcnt lgkmcnt(10)
    ds_read_b64_tr_b16 v[200:201], v9 offset:32256
    ds_read_b64_tr_b16 v[202:203], v9 offset:32768
    s_waitcnt lgkmcnt(10)
    ds_read_b64_tr_b16 v[204:205], v8 offset:34048
    ds_read_b64_tr_b16 v[206:207], v8 offset:34560
    s_waitcnt lgkmcnt(10)
    ds_read_b64_tr_b16 v[208:209], v9 offset:35840
    ds_read_b64_tr_b16 v[210:211], v9 offset:36352
    s_waitcnt lgkmcnt(10)
    ds_read_b64_tr_b16 v[212:213], v8 offset:37632
    ds_read_b64_tr_b16 v[214:215], v8 offset:38144
    s_waitcnt lgkmcnt(10)
    ds_read_b64_tr_b16 v[216:217], v9 offset:39424
    ds_read_b64_tr_b16 v[218:219], v9 offset:39936
    s_waitcnt lgkmcnt(10)
    ds_read_b64_tr_b16 v[220:221], v8 offset:41216
    ds_read_b64_tr_b16 v[222:223], v8 offset:41728
    s_waitcnt lgkmcnt(10)
    ds_read_b64_tr_b16 v[224:225], v9 offset:43008
    ds_read_b64_tr_b16 v[226:227], v9 offset:43520
    s_waitcnt lgkmcnt(10)
    ds_read_b64_tr_b16 v[228:229], v8 offset:44800
    ds_read_b64_tr_b16 v[230:231], v8 offset:45312
    s_waitcnt lgkmcnt(10)
    ds_read_b64_tr_b16 v[232:233], v9 offset:46592
    ds_read_b64_tr_b16 v[234:235], v9 offset:47104
    s_waitcnt lgkmcnt(10)
    ds_read_b64_tr_b16 v[236:237], v8 offset:48384
    ds_read_b64_tr_b16 v[238:239], v8 offset:48896
    s_waitcnt lgkmcnt(10)
    ds_read_b64_tr_b16 v[240:241], v9 offset:50176
    ds_read_b64_tr_b16 v[242:243], v9 offset:50688
    s_waitcnt lgkmcnt(10)
    ds_read_b64_tr_b16 v[244:245], v8 offset:51968
    ds_read_b64_tr_b16 v[246:247], v8 offset:52480
    s_waitcnt lgkmcnt(10)
    ds_read_b64_tr_b16 v[248:249], v9 offset:53760
    ds_read_b64_tr_b16 v[250:251], v9 offset:54272
    s_waitcnt lgkmcnt(10)
    ds_read_b64_tr_b16 v[252:253], v8 offset:55552
    ds_read_b64_tr_b16 v[254:255], v8 offset:56064
    s_waitcnt lgkmcnt(10)
    s_mov_b64 exec, 1
    ds_add_u32 v5, v6 offset:24
    s_mov_b64 exec, -1
    s_cmp_lg_u32 s26, 0
    s_cbranch_scc1 nojob_96
    s_add_u32 m0, s73, 0
    s_add_u32 s62, s72, 0
    buffer_load_dwordx4 v10, s[12:15], s62 offen lds
    s_add_u32 m0, s73, 1024
    s_add_u32 s62, s72, 7168
    buffer_load_dwordx4 v10, s[12:15], s62 offen lds
    s_add_u32 m0, s73, 2048
    s_add_u32 s62, s72, 14336
    buffer_load_dwordx4 v10, s[12:15], s62 offen lds
    s_add_u32 m0, s73, 3072
    s_add_u32 s62, s72, 21504
    buffer_load_dwordx4 v10, s[12:15], s62 offen lds
    s_waitcnt vmcnt(6)
    s_add_u32 m0, s73, 4096
    s_add_u32 s62, s72, 28672
    buffer_load_dwordx4 v10, s[12:15], s62 offen lds
    s_add_u32 m0, s73, 5120
    s_add_u32 s62, s72, 35840
    buffer_load_dwordx4 v10, s[12:15], s62 offen lds
    s_add_u32 m0, s73, 6144
    s_add_u32 s62, s72, 43008
    buffer_load_dwordx4 v10, s[12:15], s62 offen lds
    s_add_u32 m0, s73, 7168
    s_add_u32 s62, s72, 50176
    buffer_load_dwordx4 v10, s[12:15], s62 offen lds
    s_waitcnt vmcnt(6)
    s_add_u32 m0, s73, 8192
    s_add_u32 s62, s72, 57344
    buffer_load_dwordx4 v10, s[12:15], s62 offen lds
    s_add_u32 m0, s73, 9216
    s_add_u32 s62, s72, 64512
    buffer_load_dwordx4 v10, s[12:15], s62 offen lds
    s_add_u32 m0, s73, 10240
    s_add_u32 s62, s72, 71680
    buffer_load_dwordx4 v10, s[12:15], s62 offen lds
    s_add_u32 m0, s73, 11264
    s_add_u32 s62, s72, 78848
    buffer_load_dwordx4 v10, s[12:15], s62 offen lds
    s_waitcnt vmcnt(6)
    s_add_u32 m0, s73, 12288
    s_add_u32 s62, s72, 86016
    buffer_load_dwordx4 v10, s[12:15], s62 offen lds
    s_add_u32 m0, s73, 13312
    s_add_u32 s62, s72, 93184
    buffer_load_dwordx4 v10, s[12:15], s62 offen lds
    s_waitcnt vmcnt(6)
    s_add_u32 m0, s73, 14336
    s_add_u32 s62, s72, 100352
    s_cmp_lg_u32 s25, 3
    s_cbranch_scc1 nojob_96
    buffer_load_dwordx4 v10, s[12:15], s62 offen lds
nojob_96:
    s_setprio 1
    s_cmp_lg_u32 s25, 0
    s_cbranch_scc1 np_97
    s_mov_b32 s60, 721024
    s_mov_b32 s61, 60000
    s_mov_b64 exec, 0xffff
poll_98:
    buffer_load_dwordx2 v[20:21], v19, s[16:19], s60 offen sc1
    s_waitcnt vmcnt(0)
    v_xor_b32 v20, s58, v20
    v_xor_b32 v21, s58, v21
    v_or_b32 v20, v20, v21
    v_cmp_ne_u32 vcc, 0, v20
    s_sub_u32 s61, s61, 1
    s_cselect_b64 vcc, 0, vcc
    s_cmp_eq_u64 vcc, 0
    s_cbranch_scc1 pdone_99
    s_sleep 4
    s_branch poll_98
pdone_99:
    s_mov_b64 exec, -1
    s_mov_b64 exec, 1
    ds_add_u32 v5, v6 offset:96
    s_mov_b64 exec, -1
    s_waitcnt lgkmcnt(0)
    s_wakeup
np_97:
    s_mov_b32 s61, 300000
lw_100:
    ds_read_b32 v12, v5 offset:96
    s_waitcnt lgkmcnt(0)
    v_readfirstlane_b32 s60, v12
    s_sub_u32 s61, s61, 1
    s_cbranch_scc1 lwd_101
    s_cmp_ge_u32 s60, 1
    s_cbranch_scc1 lwd_101
    s_sleep 8
    s_branch lw_100
lwd_101:
    s_mov_b32 s61, 300000
lw_102:
    ds_read_b32 v12, v5 offset:24
    s_waitcnt lgkmcnt(0)
    v_readfirstlane_b32 s60, v12
    s_sub_u32 s61, s61, 1
    s_cbranch_scc1 lwd_103
    s_cmp_ge_u32 s60, 8
    s_cbranch_scc1 lwd_103
    s_sleep 1
    s_branch lw_102
lwd_103:
    s_setprio 0
    s_add_u32 s64, s74, s28
    s_lshl_b32 s64, s64, 15
    s_lshl_b32 s65, s29, 13
    s_add_u32 s75, s64, s65
    s_add_u32 s75, s75, 1048576
    s_lshl_b32 s76, s25, 13
    s_lshl_b32 s64, s28, 14
    s_add_u32 s64, s64, 58368
    v_add_u32 v13, s64, v2
    s_add_u32 s66, s75, 4096
    s_add_u32 m0, s76, 58368
    s_nop 0
    buffer_load_dwordx4 v2, s[16:19], s75 offen offset:0 sc1 lds
    buffer_load_dwordx4 v2, s[16:19], s75 offen offset:1024 sc1 lds
    buffer_load_dwordx4 v2, s[16:19], s75 offen offset:2048 sc1 lds
    buffer_load_dwordx4 v2, s[16:19], s75 offen offset:3072 sc1 lds
    s_add_u32 m0, s76, 62464
    s_nop 0
    buffer_load_dwordx4 v2, s[16:19], s66 offen offset:0 sc1 lds
    buffer_load_dwordx4 v2, s[16:19], s66 offen offset:1024 sc1 lds
    buffer_load_dwordx4 v2, s[16:19], s66 offen offset:2048 sc1 lds
    buffer_load_dwordx4 v2, s[16:19], s66 offen offset:3072 sc1 lds
    s_sub_u32 s64, s75, s65
    s_add_u32 s66, s64, 16384
    buffer_load_dwordx4 v[48:51], v2, s[16:19], s66 offen offset:0 sc1
    s_waitcnt vmcnt(10)
    buffer_load_dwordx4 v[52:55], v2, s[16:19], s66 offen offset:1024 sc1
    s_waitcnt vmcnt(10)
    buffer_load_dwordx4 v[56:59], v2, s[16:19], s66 offen offset:2048 sc1
    s_waitcnt vmcnt(10)
    buffer_load_dwordx4 v[60:63], v2, s[16:19], s66 offen offset:3072 sc1
    s_waitcnt vmcnt(10)
    s_add_u32 s66, s64, 20480
    buffer_load_dwordx4 v[64:67], v2, s[16:19], s66 offen offset:0 sc1
    s_waitcnt vmcnt(10)
    buffer_load_dwordx4 v[68:71], v2, s[16:19], s66 offen offset:1024 sc1
    s_waitcnt vmcnt(10)
    buffer_load_dwordx4 v[72:75], v2, s[16:19], s66 offen offset:2048 sc1
    s_waitcnt vmcnt(10)
    buffer_load_dwordx4 v[76:79], v2, s[16:19], s66 offen offset:3072 sc1
    s_waitcnt vmcnt(10)
    s_add_u32 s66, s64, 24576
    buffer_load_dwordx4 v[80:83], v2, s[16:19], s66 offen offset:0 sc1
    s_waitcnt vmcnt(10)
    buffer_load_dwordx4 v[84:87], v2, s[16:19], s66 offen offset:1024 sc1
    s_waitcnt vmcnt(10)
    buffer_load_dwordx4 v[88:91], v2, s[16:19], s66 offen offset:2048 sc1
    s_waitcnt vmcnt(10)
    buffer_load_dwordx4 v[92:95], v2, s[16:19], s66 offen offset:3072 sc1
    s_waitcnt vmcnt(10)
    s_add_u32 s66, s64, 28672
    buffer_load_dwordx4 v[96:99], v2, s[16:19], s66 offen offset:0 sc1
    s_waitcnt vmcnt(10)
    buffer_load_dwordx4 v[100:103], v2, s[16:19], s66 offen offset:1024 sc1
    s_waitcnt vmcnt(10)
    buffer_load_dwordx4 v[104:107], v2, s[16:19], s66 offen offset:2048 sc1
    s_waitcnt vmcnt(10)
    buffer_load_dwordx4 v[108:111], v2, s[16:19], s66 offen offset:3072 sc1
    s_waitcnt vmcnt(10)
    s_waitcnt vmcnt(0)
    s_mov_b64 exec, 1
    ds_add_u32 v5, v6 offset:28
    s_mov_b64 exec, -1
    s_mov_b32 s61, 300000
lw_104:
    ds_read_b32 v12, v5 offset:60
    s_waitcnt lgkmcnt(0)
    v_readfirstlane_b32 s60, v12
    s_sub_u32 s61, s61, 1
    s_cbranch_scc1 lwd_105
    s_cmp_ge_u32 s60, 4
    s_cbranch_scc1 lwd_105
    s_sleep 8
    s_branch lw_104
lwd_105:
    s_setprio 0
    s_mov_b32 s61, 300000
lw_106:
    ds_read_b32 v12, v5 offset:28
    s_waitcnt lgkmcnt(0)
    v_readfirstlane_b32 s60, v12
    s_sub_u32 s61, s61, 1
    s_cbranch_scc1 lwd_107
    s_cmp_ge_u32 s60, 4
    s_cbranch_scc1 lwd_107
    s_branch lw_106
lwd_107:
    ds_read_b64_tr_b16 v[24:25], v11 offset:28672
    ds_read_b64_tr_b16 v[26:27], v11 offset:29696
    ds_read_b64_tr_b16 v[28:29], v11 offset:30720
    ds_read_b64_tr_b16 v[30:31], v11 offset:31744
    ds_read_b64_tr_b16 v[32:33], v11 offset:32256
    ds_read_b64_tr_b16 v[34:35], v11 offset:33280
    ds_read_b64_tr_b16 v[36:37], v11 offset:34304
    ds_read_b64_tr_b16 v[38:39], v11 offset:35328
    s_waitcnt lgkmcnt(6)
    v_mfma_f32_32x32x16_bf16 v[112:127], v[24:27], v[48:51], 0
    ds_read_b64_tr_b16 v[40:41], v11 offset:35840
    ds_read_b64_tr_b16 v[42:43], v11 offset:36864
    s_waitcnt lgkmcnt(6)
    v_mfma_f32_32x32x16_bf16 v[112:127], v[28:31], v[52:55], v[112:127]
    ds_read_b64_tr_b16 v[44:45], v11 offset:37888
    ds_read_b64_tr_b16 v[46:47], v11 offset:38912
    s_waitcnt lgkmcnt(6)
    v_mfma_f32_32x32x16_bf16 v[112:127], v[32:35], v[56:59], v[112:127]
    ds_read_b64_tr_b16 v[24:25], v11 offset:39424
    ds_read_b64_tr_b16 v[26:27], v11 offset:40448
    s_waitcnt lgkmcnt(6)
    v_mfma_f32_32x32x16_bf16 v[112:127], v[36:39], v[60:63], v[112:127]
    ds_read_b64_tr_b16 v[28:29], v11 offset:41472
    ds_read_b64_tr_b16 v[30:31], v11 offset:42496
    s_waitcnt lgkmcnt(6)
    v_mfma_f32_32x32x16_bf16 v[112:127], v[40:43], v[64:67], v[112:127]
    ds_read_b64_tr_b16 v[32:33], v11 offset:43008
    ds_read_b64_tr_b16 v[34:35], v11 offset:44032
    s_waitcnt lgkmcnt(6)
    v_mfma_f32_32x32x16_bf16 v[112:127], v[44:47], v[68:71], v[112:127]
    ds_read_b64_tr_b16 v[36:37], v11 offset:45056
    ds_read_b64_tr_b16 v[38:39], v11 offset:46080
    s_waitcnt lgkmcnt(6)
    v_mfma_f32_32x32x16_bf16 v[112:127], v[24:27], v[72:75], v[112:127]
    ds_read_b64_tr_b16 v[40:41], v11 offset:46592
    ds_read_b64_tr_b16 v[42:43], v11 offset:47616
    s_waitcnt lgkmcnt(6)
    v_mfma_f32_32x32x16_bf16 v[112:127], v[28:31], v[76:79], v[112:127]
    ds_read_b64_tr_b16 v[44:45], v11 offset:48640
    ds_read_b64_tr_b16 v[46:47], v11 offset:49664
    s_waitcnt lgkmcnt(6)
    v_mfma_f32_32x32x16_bf16 v[112:127], v[32:35], v[80:83], v[112:127]
    ds_read_b64_tr_b16 v[24:25], v11 offset:50176
    ds_read_b64_tr_b16 v[26:27], v11 offset:51200
    s_waitcnt lgkmcnt(6)
    v_mfma_f32_32x32x16_bf16 v[112:127], v[36:39], v[84:87], v[112:127]
    ds_read_b64_tr_b16 v[28:29], v11 offset:52224
    ds_read_b64_tr_b16 v[30:31], v11 offset:53248
    s_waitcnt lgkmcnt(6)
    v_mfma_f32_32x32x16_bf16 v[112:127], v[40:43], v[88:91], v[112:127]
    ds_read_b64_tr_b16 v[32:33], v11 offset:53760
    ds_read_b64_tr_b16 v[34:35], v11 offset:54784
    s_waitcnt lgkmcnt(6)
    v_mfma_f32_32x32x16_bf16 v[112:127], v[44:47], v[92:95], v[112:127]
    ds_read_b64_tr_b16 v[36:37], v11 offset:55808
    ds_read_b64_tr_b16 v[38:39], v11 offset:56832
    s_waitcnt lgkmcnt(6)
    v_mfma_f32_32x32x16_bf16 v[112:127], v[24:27], v[96:99], v[112:127]
    ds_read_b128 v[48:51], v13 offset:0
    ds_read_b64_tr_b16 v[40:41], v11 offset:0
    ds_read_b64_tr_b16 v[42:43], v11 offset:1024
    s_waitcnt lgkmcnt(7)
    v_mfma_f32_32x32x16_bf16 v[112:127], v[28:31], v[100:103], v[112:127]
    ds_read_b128 v[52:55], v13 offset:1024
    ds_read_b64_tr_b16 v[44:45], v11 offset:2048
    ds_read_b64_tr_b16 v[46:47], v11 offset:3072
    s_waitcnt lgkmcnt(8)
    v_mfma_f32_32x32x16_bf16 v[112:127], v[32:35], v[104:107], v[112:127]
    ds_read_b128 v[56:59], v13 offset:2048
    ds_read_b64_tr_b16 v[24:25], v11 offset:3584
    ds_read_b64_tr_b16 v[26:27], v11 offset:4608
    s_waitcnt lgkmcnt(9)
    v_mfma_f32_32x32x16_bf16 v[112:127], v[36:39], v[108:111], v[112:127]
    ds_read_b128 v[60:63], v13 offset:3072
    ds_read_b64_tr_b16 v[28:29], v11 offset:5632
    ds_read_b64_tr_b16 v[30:31], v11 offset:6656
    s_waitcnt lgkmcnt(9)
    v_mfma_f32_32x32x16_bf16 v[112:127], v[40:43], v[48:51], v[112:127]
    ds_read_b128 v[64:67], v13 offset:4096
    ds_read_b64_tr_b16 v[32:33], v11 offset:7168
    ds_read_b64_tr_b16 v[34:35], v11 offset:8192
    s_waitcnt lgkmcnt(9)
    v_mfma_f32_32x32x16_bf16 v[112:127], v[44:47], v[52:55], v[112:127]
    ds_read_b128 v[68:71], v13 offset:5120
    ds_read_b64_tr_b16 v[36:37], v11 offset:9216
    ds_read_b64_tr_b16 v[38:39], v11 offset:10240
    s_waitcnt lgkmcnt(9)
    v_mfma_f32_32x32x16_bf16 v[112:127], v[24:27], v[56:59], v[112:127]
    ds_read_b128 v[72:75], v13 offset:6144
    ds_read_b64_tr_b16 v[40:41], v11 offset:10752
    ds_read_b64_tr_b16 v[42:43], v11 offset:11776
    s_waitcnt lgkmcnt(9)
    v_mfma_f32_32x32x16_bf16 v[112:127], v[28:31], v[60:63], v[112:127]
    ds_read_b128 v[76:79], v13 offset:7168
    ds_read_b64_tr_b16 v[44:45], v11 offset:12800
    ds_read_b64_tr_b16 v[46:47], v11 offset:13824
    s_waitcnt lgkmcnt(9)
    v_mfma_f32_32x32x16_bf16 v[112:127], v[32:35], v[64:67], v[112:127]
    ds_read_b128 v[80:83], v13 offset:8192
    ds_read_b64_tr_b16 v[24:25], v11 offset:14336
    ds_read_b64_tr_b16 v[26:27], v11 offset:15360
    s_waitcnt lgkmcnt(9)
    v_mfma_f32_32x32x16_bf16 v[112:127], v[36:39], v[68:71], v[112:127]
    ds_read_b128 v[84:87], v13 offset:9216
    ds_read_b64_tr_b16 v[28:29], v11 offset:16384
    ds_read_b64_tr_b16 v[30:31], v11 offset:17408
    s_waitcnt lgkmcnt(9)
    v_mfma_f32_32x32x16_bf16 v[112:127], v[40:43], v[72:75], v[112:127]
    ds_read_b128 v[88:91], v13 offset:10240
    ds_read_b64_tr_b16 v[32:33], v11 offset:17920
    ds_read_b64_tr_b16 v[34:35], v11 offset:18944
    s_waitcnt lgkmcnt(9)
    v_mfma_f32_32x32x16_bf16 v[112:127], v[44:47], v[76:79], v[112:127]
    ds_read_b128 v[92:95], v13 offset:11264
    ds_read_b64_tr_b16 v[36:37], v11 offset:19968
    ds_read_b64_tr_b16 v[38:39], v11 offset:20992
    s_waitcnt lgkmcnt(9)
    v_mfma_f32_32x32x16_bf16 v[112:127], v[24:27], v[80:83], v[112:127]
    ds_read_b128 v[96:99], v13 offset:12288
    ds_read_b64_tr_b16 v[40:41], v11 offset:21504
    ds_read_b64_tr_b16 v[42:43], v11 offset:22528
    s_waitcnt lgkmcnt(9)
    v_mfma_f32_32x32x16_bf16 v[112:127], v[28:31], v[84:87], v[112:127]
    ds_read_b128 v[100:103], v13 offset:13312
    ds_read_b64_tr_b16 v[44:45], v11 offset:23552
    ds_read_b64_tr_b16 v[46:47], v11 offset:24576
    s_waitcnt lgkmcnt(9)
    v_mfma_f32_32x32x16_bf16 v[112:127], v[32:35], v[88:91], v[112:127]
    ds_read_b128 v[104:107], v13 offset:14336
    ds_read_b64_tr_b16 v[24:25], v11 offset:25088
    ds_read_b64_tr_b16 v[26:27], v11 offset:26112
    s_waitcnt lgkmcnt(9)
    v_mfma_f32_32x32x16_bf16 v[112:127], v[36:39], v[92:95], v[112:127]
    ds_read_b128 v[108:111], v13 offset:15360
    ds_read_b64_tr_b16 v[28:29], v11 offset:27136
    ds_read_b64_tr_b16 v[30:31], v11 offset:28160
    s_waitcnt lgkmcnt(9)
    v_mfma_f32_32x32x16_bf16 v[112:127], v[40:43], v[96:99], v[112:127]
    s_waitcnt lgkmcnt(6)
    v_mfma_f32_32x32x16_bf16 v[112:127], v[44:47], v[100:103], v[112:127]
    s_waitcnt lgkmcnt(3)
    v_mfma_f32_32x32x16_bf16 v[112:127], v[24:27], v[104:107], v[112:127]
    s_waitcnt lgkmcnt(0)
    v_mfma_f32_32x32x16_bf16 v[112:127], v[28:31], v[108:111], v[112:127]
    s_mov_b32 s84, s52
    s_mov_b32 s85, s53
    s_mov_b32 s86, 1835008
    s_mov_b32 s87, 0x00020000
    v_mul_u32_u24 v10, 896, v3
    v_lshl_add_u32 v10, v4, 4, v10
    s_add_u32 s73, s74, s28
    s_mul_i32 s73, s73, 28672
    s_lshl_b32 s65, s71, 7
    s_add_u32 s73, s73, s65
    s_lshl_b32 s65, s29, 6
    s_add_u32 s73, s73, s65
    s_lshl_b32 s64, s28, 15
    s_add_u32 s64, s64, 91136
    v_add_u32 v13, s64, v2
    v_and_b32 v131, 0xffff, v131
    v_and_b32 v135, 0xffff, v135
    v_and_b32 v139, 0xffff, v139
    v_and_b32 v143, 0xffff, v143
    v_and_b32 v147, 0xffff, v147
    v_and_b32 v151, 0xffff, v151
    v_and_b32 v155, 0xffff, v155
    v_and_b32 v159, 0xffff, v159
    v_and_b32 v163, 0xffff, v163
    v_and_b32 v167, 0xffff, v167
    v_and_b32 v171, 0xffff, v171
    v_and_b32 v175, 0xffff, v175
    v_and_b32 v179, 0xffff, v179
    v_and_b32 v183, 0xffff, v183
    v_and_b32 v187, 0xffff, v187
    v_and_b32 v191, 0xffff, v191
    v_and_b32 v195, 0xffff, v195
    v_and_b32 v199, 0xffff, v199
    v_and_b32 v203, 0xffff, v203
    v_and_b32 v207, 0xffff, v207
    v_and_b32 v211, 0xffff, v211
    v_and_b32 v215, 0xffff, v215
    v_and_b32 v219, 0xffff, v219
    v_and_b32 v223, 0xffff, v223
    v_and_b32 v227, 0xffff, v227
    v_and_b32 v231, 0xffff, v231
    v_and_b32 v235, 0xffff, v235
    v_and_b32 v239, 0xffff, v239
    v_and_b32 v243, 0xffff, v243
    v_and_b32 v247, 0xffff, v247
    v_and_b32 v251, 0xffff, v251
    v_and_b32 v255, 0xffff, v255
    s_mov_b32 s61, 300000
lw_108:
    ds_read_b32 v12, v5 offset:112
    s_waitcnt lgkmcnt(0)
    v_readfirstlane_b32 s60, v12
    s_sub_u32 s61, s61, 1
    s_cbranch_scc1 lwd_109
    s_cmp_ge_u32 s60, 4
    s_cbranch_scc1 lwd_109
    s_branch lw_108
lwd_109:
    ds_read_b128 v[48:51], v13 offset:0
    ds_read_b128 v[52:55], v13 offset:1024
    ds_read_b128 v[56:59], v13 offset:2048
    ds_read_b128 v[60:63], v13 offset:3072
    ds_read_b128 v[64:67], v13 offset:4096
    ds_read_b128 v[68:71], v13 offset:5120
    ds_read_b128 v[72:75], v13 offset:6144
    ds_read_b128 v[76:79], v13 offset:7168
    ds_read_b32 v14, v5 offset:116
    s_waitcnt lgkmcnt(8)
    v_mfma_f32_32x32x16_bf16 v[112:127], v[128:131], v[48:51], v[112:127]
    s_waitcnt lgkmcnt(7)
    v_mfma_f32_32x32x16_bf16 v[112:127], v[132:135], v[52:55], v[112:127]
    s_waitcnt lgkmcnt(6)
    v_mfma_f32_32x32x16_bf16 v[112:127], v[136:139], v[56:59], v[112:127]
    s_waitcnt lgkmcnt(5)
    v_mfma_f32_32x32x16_bf16 v[112:127], v[140:143], v[60:63], v[112:127]
    s_waitcnt lgkmcnt(0)
    v_readfirstlane_b32 s60, v14
    v_mfma_f32_32x32x16_bf16 v[112:127], v[144:147], v[64:67], v[112:127]
    s_cmp_ge_u32 s60, 4
    s_cbranch_scc0 cslow_110
    ds_read_b128 v[80:83], v13 offset:8192
    ds_read_b128 v[84:87], v13 offset:9216
    ds_read_b128 v[88:91], v13 offset:10240
    v_mfma_f32_32x32x16_bf16 v[112:127], v[148:151], v[68:71], v[112:127]
    ds_read_b128 v[92:95], v13 offset:11264
    ds_read_b128 v[96:99], v13 offset:12288
    ds_read_b128 v[100:103], v13 offset:13312
    v_mfma_f32_32x32x16_bf16 v[112:127], v[152:155], v[72:75], v[112:127]
    ds_read_b128 v[104:107], v13 offset:14336
    ds_read_b128 v[108:111], v13 offset:15360
    ds_read_b32 v14, v5 offset:120
    v_mfma_f32_32x32x16_bf16 v[112:127], v[156:159], v[76:79], v[112:127]
cok_111:
    s_waitcnt lgkmcnt(8)
    v_mfma_f32_32x32x16_bf16 v[112:127], v[160:163], v[80:83], v[112:127]
    s_waitcnt lgkmcnt(7)
    v_mfma_f32_32x32x16_bf16 v[112:127], v[164:167], v[84:87], v[112:127]
    s_waitcnt lgkmcnt(6)
    v_mfma_f32_32x32x16_bf16 v[112:127], v[168:171], v[88:91], v[112:127]
    s_waitcnt lgkmcnt(5)
    v_mfma_f32_32x32x16_bf16 v[112:127], v[172:175], v[92:95], v[112:127]
    s_waitcnt lgkmcnt(0)
    v_readfirstlane_b32 s60, v14
    v_mfma_f32_32x32x16_bf16 v[112:127], v[176:179], v[96:99], v[112:127]
    s_cmp_ge_u32 s60, 4
    s_cbranch_scc0 cslow_112
    ds_read_b128 v[48:51], v13 offset:16384
    ds_read_b128 v[52:55], v13 offset:17408
    ds_read_b128 v[56:59], v13 offset:18432
    v_mfma_f32_32x32x16_bf16 v[112:127], v[180:183], v[100:103], v[112:127]
    ds_read_b128 v[60:63], v13 offset:19456
    ds_read_b128 v[64:67], v13 offset:20480
    ds_read_b128 v[68:71], v13 offset:21504
    v_mfma_f32_32x32x16_bf16 v[112:127], v[184:187], v[104:107], v[112:127]
    ds_read_b128 v[72:75], v13 offset:22528
    ds_read_b128 v[76:79], v13 offset:23552
    ds_read_b32 v14, v5 offset:124
    v_mfma_f32_32x32x16_bf16 v[112:127], v[188:191], v[108:111], v[112:127]
cok_113:
    s_waitcnt lgkmcnt(8)
    v_mfma_f32_32x32x16_bf16 v[112:127], v[192:195], v[48:51], v[112:127]
    s_waitcnt lgkmcnt(7)
    v_mfma_f32_32x32x16_bf16 v[112:127], v[196:199], v[52:55], v[112:127]
    s_waitcnt lgkmcnt(6)
    v_mfma_f32_32x32x16_bf16 v[112:127], v[200:203], v[56:59], v[112:127]
    s_waitcnt lgkmcnt(5)
    v_mfma_f32_32x32x16_bf16 v[112:127], v[204:207], v[60:63], v[112:127]
    s_waitcnt lgkmcnt(0)
    v_readfirstlane_b32 s60, v14
    v_mfma_f32_32x32x16_bf16 v[112:127], v[208:211], v[64:67], v[112:127]
    s_cmp_ge_u32 s60, 4
    s_cbranch_scc0 cslow_114
    ds_read_b128 v[80:83], v13 offset:24576
    ds_read_b128 v[84:87], v13 offset:25600
    ds_read_b128 v[88:91], v13 offset:26624
    v_mfma_f32_32x32x16_bf16 v[112:127], v[212:215], v[68:71], v[112:127]
    ds_read_b128 v[92:95], v13 offset:27648
    ds_read_b128 v[96:99], v13 offset:28672
    ds_read_b128 v[100:103], v13 offset:29696
    v_mfma_f32_32x32x16_bf16 v[112:127], v[216:219], v[72:75], v[112:127]
    ds_read_b128 v[104:107], v13 offset:30720
    ds_read_b128 v[108:111], v13 offset:31744
    v_mfma_f32_32x32x16_bf16 v[112:127], v[220:223], v[76:79], v[112:127]
cok_115:
    s_waitcnt lgkmcnt(7)
    v_mfma_f32_32x32x16_bf16 v[112:127], v[224:227], v[80:83], v[112:127]
    s_waitcnt lgkmcnt(6)
    v_mfma_f32_32x32x16_bf16 v[112:127], v[228:231], v[84:87], v[112:127]
    s_waitcnt lgkmcnt(5)
    v_mfma_f32_32x32x16_bf16 v[112:127], v[232:235], v[88:91], v[112:127]
    s_waitcnt lgkmcnt(4)
    v_mfma_f32_32x32x16_bf16 v[112:127], v[236:239], v[92:95], v[112:127]
    s_waitcnt lgkmcnt(0)
    v_mfma_f32_32x32x16_bf16 v[112:127], v[240:243], v[96:99], v[112:127]
    v_mfma_f32_32x32x16_bf16 v[112:127], v[244:247], v[100:103], v[112:127]
    v_mfma_f32_32x32x16_bf16 v[112:127], v[248:251], v[104:107], v[112:127]
    v_mfma_f32_32x32x16_bf16 v[112:127], v[252:255], v[108:111], v[112:127]
    s_nop 11
    v_cvt_pk_bf16_f32 v24, v112, v113
    v_cvt_pk_bf16_f32 v25, v114, v115
    v_cvt_pk_bf16_f32 v26, v116, v117
    v_cvt_pk_bf16_f32 v27, v118, v119
    v_cvt_pk_bf16_f32 v28, v120, v121
    v_cvt_pk_bf16_f32 v29, v122, v123
    v_cvt_pk_bf16_f32 v30, v124, v125
    v_cvt_pk_bf16_f32 v31, v126, v127
    v_permlane32_swap_b32 v24, v26
    v_permlane32_swap_b32 v25, v27
    v_permlane32_swap_b32 v28, v30
    v_permlane32_swap_b32 v29, v31
    buffer_store_dwordx4 v[24:27], v10, s[84:87], s73 offen offset:0
    buffer_store_dwordx4 v[28:31], v10, s[84:87], s73 offen offset:32
L_tag:
    s_lshl_b32 s60, s25, 8
    s_add_u32 s60, s60, s79
    s_cmp_lg_u32 s60, 1
    s_cbranch_scc1 L_fin
    v_mov_b32 v12, 0
    v_mov_b32 v13, s58
    s_mov_b32 s60, 655360
    s_mov_b64 exec, 1
    buffer_store_dword v13, v12, s[16:19], s60 offen
    s_mov_b64 exec, -1
    s_branch L_fin
fslow_32:
    v_mfma_f32_32x32x16_bf16 v[240:255], v[180:183], v[64:67], 0
    v_mfma_f32_32x32x16_bf16 v[224:239], v[184:187], v[68:71], v[224:239]
    v_mfma_f32_32x32x16_bf16 v[240:255], v[188:191], v[68:71], v[240:255]
    v_mfma_f32_32x32x16_bf16 v[224:239], v[192:195], v[72:75], v[224:239]
    v_mfma_f32_32x32x16_bf16 v[240:255], v[196:199], v[72:75], v[240:255]
    v_mfma_f32_32x32x16_bf16 v[224:239], v[200:203], v[76:79], v[224:239]
    v_mfma_f32_32x32x16_bf16 v[240:255], v[204:207], v[76:79], v[240:255]
    s_mov_b32 s61, 300000
lw_116:
    ds_read_b32 v12, v5 offset:132
    s_waitcnt lgkmcnt(0)
    v_readfirstlane_b32 s60, v12
    s_sub_u32 s61, s61, 1
    s_cbranch_scc1 lwd_117
    s_cmp_ge_u32 s60, 4
    s_cbranch_scc1 lwd_117
    s_branch lw_116
lwd_117:
    ds_read_b128 v[80:83], v40 offset:4096
    ds_read_b128 v[84:87], v41 offset:4096
    ds_read_b128 v[88:91], v42 offset:4096
    ds_read_b128 v[92:95], v43 offset:4096
    s_mov_b64 exec, 1
    ds_add_u32 v5, v6 offset:164
    s_mov_b64 exec, -1
    ds_read_b64_tr_b16 v[208:209], v17 offset:4096
    ds_read_b64_tr_b16 v[210:211], v17 offset:4352
    ds_read_b64_tr_b16 v[212:213], v17 offset:32768
    ds_read_b64_tr_b16 v[214:215], v17 offset:33024
    ds_read_b64_tr_b16 v[216:217], v17 offset:5120
    ds_read_b64_tr_b16 v[218:219], v17 offset:5376
    ds_read_b64_tr_b16 v[220:221], v17 offset:33792
    ds_read_b64_tr_b16 v[222:223], v17 offset:34048
    ds_read_b64_tr_b16 v[48:49], v17 offset:6144
    ds_read_b64_tr_b16 v[50:51], v17 offset:6400
    ds_read_b64_tr_b16 v[52:53], v17 offset:34816
    ds_read_b64_tr_b16 v[54:55], v17 offset:35072
    ds_read_b64_tr_b16 v[56:57], v17 offset:7168
    ds_read_b64_tr_b16 v[58:59], v17 offset:7424
    ds_read_b64_tr_b16 v[60:61], v17 offset:35840
    ds_read_b64_tr_b16 v[62:63], v17 offset:36096
    ds_read_b32 v13, v5 offset:136
    s_branch fok_33
fslow_34:
    v_mfma_f32_32x32x16_bf16 v[240:255], v[212:215], v[80:83], v[240:255]
    v_mfma_f32_32x32x16_bf16 v[224:239], v[216:219], v[84:87], v[224:239]
    v_mfma_f32_32x32x16_bf16 v[240:255], v[220:223], v[84:87], v[240:255]
    v_mfma_f32_32x32x16_bf16 v[224:239], v[48:51], v[88:91], v[224:239]
    v_mfma_f32_32x32x16_bf16 v[240:255], v[52:55], v[88:91], v[240:255]
    v_mfma_f32_32x32x16_bf16 v[224:239], v[56:59], v[92:95], v[224:239]
    v_mfma_f32_32x32x16_bf16 v[240:255], v[60:63], v[92:95], v[240:255]
    s_mov_b32 s61, 300000
lw_118:
    ds_read_b32 v12, v5 offset:136
    s_waitcnt lgkmcnt(0)
    v_readfirstlane_b32 s60, v12
    s_sub_u32 s61, s61, 1
    s_cbranch_scc1 lwd_119
    s_cmp_ge_u32 s60, 4
    s_cbranch_scc1 lwd_119
    s_branch lw_118
lwd_119:
    ds_read_b128 v[96:99], v40 offset:8192
    ds_read_b128 v[100:103], v41 offset:8192
    ds_read_b128 v[104:107], v42 offset:8192
    ds_read_b128 v[108:111], v43 offset:8192
    s_mov_b64 exec, 1
    ds_add_u32 v5, v6 offset:168
    s_mov_b64 exec, -1
    ds_read_b64_tr_b16 v[176:177], v17 offset:8192
    ds_read_b64_tr_b16 v[178:179], v17 offset:8448
    ds_read_b64_tr_b16 v[180:181], v17 offset:36864
    ds_read_b64_tr_b16 v[182:183], v17 offset:37120
    ds_read_b64_tr_b16 v[184:185], v17 offset:9216
    ds_read_b64_tr_b16 v[186:187], v17 offset:9472
    ds_read_b64_tr_b16 v[188:189], v17 offset:37888
    ds_read_b64_tr_b16 v[190:191], v17 offset:38144
    ds_read_b64_tr_b16 v[192:193], v17 offset:10240
    ds_read_b64_tr_b16 v[194:195], v17 offset:10496
    ds_read_b64_tr_b16 v[196:197], v17 offset:38912
    ds_read_b64_tr_b16 v[198:199], v17 offset:39168
    ds_read_b64_tr_b16 v[200:201], v17 offset:11264
    ds_read_b64_tr_b16 v[202:203], v17 offset:11520
    ds_read_b64_tr_b16 v[204:205], v17 offset:39936
    ds_read_b64_tr_b16 v[206:207], v17 offset:40192
    ds_read_b32 v13, v5 offset:140
    s_branch fok_35
fslow_36:
    v_mfma_f32_32x32x16_bf16 v[240:255], v[180:183], v[96:99], v[240:255]
    v_mfma_f32_32x32x16_bf16 v[224:239], v[184:187], v[100:103], v[224:239]
    v_mfma_f32_32x32x16_bf16 v[240:255], v[188:191], v[100:103], v[240:255]
    v_mfma_f32_32x32x16_bf16 v[224:239], v[192:195], v[104:107], v[224:239]
    v_mfma_f32_32x32x16_bf16 v[240:255], v[196:199], v[104:107], v[240:255]
    v_mfma_f32_32x32x16_bf16 v[224:239], v[200:203], v[108:111], v[224:239]
    v_mfma_f32_32x32x16_bf16 v[240:255], v[204:207], v[108:111], v[240:255]
    s_mov_b32 s61, 300000
lw_120:
    ds_read_b32 v12, v5 offset:140
    s_waitcnt lgkmcnt(0)
    v_readfirstlane_b32 s60, v12
    s_sub_u32 s61, s61, 1
    s_cbranch_scc1 lwd_121
    s_cmp_ge_u32 s60, 4
    s_cbranch_scc1 lwd_121
    s_branch lw_120
lwd_121:
    ds_read_b128 v[112:115], v40 offset:12288
    ds_read_b128 v[116:119], v41 offset:12288
    ds_read_b128 v[120:123], v42 offset:12288
    ds_read_b128 v[124:127], v43 offset:12288
    ds_read_b64_tr_b16 v[208:209], v17 offset:12288
    ds_read_b64_tr_b16 v[210:211], v17 offset:12544
    ds_read_b64_tr_b16 v[212:213], v17 offset:40960
    ds_read_b64_tr_b16 v[214:215], v17 offset:41216
    ds_read_b64_tr_b16 v[216:217], v17 offset:13312
    ds_read_b64_tr_b16 v[218:219], v17 offset:13568
    ds_read_b64_tr_b16 v[220:221], v17 offset:41984
    ds_read_b64_tr_b16 v[222:223], v17 offset:42240
    ds_read_b64_tr_b16 v[48:49], v17 offset:14336
    ds_read_b64_tr_b16 v[50:51], v17 offset:14592
    ds_read_b64_tr_b16 v[52:53], v17 offset:43008
    ds_read_b64_tr_b16 v[54:55], v17 offset:43264
    ds_read_b64_tr_b16 v[56:57], v17 offset:15360
    ds_read_b64_tr_b16 v[58:59], v17 offset:15616
    ds_read_b64_tr_b16 v[60:61], v17 offset:44032
    ds_read_b64_tr_b16 v[62:63], v17 offset:44288
    ds_read_b32 v13, v5 offset:144
    s_branch fok_37
fslow_38:
    v_mfma_f32_32x32x16_bf16 v[240:255], v[212:215], v[112:115], v[240:255]
    v_mfma_f32_32x32x16_bf16 v[224:239], v[216:219], v[116:119], v[224:239]
    v_mfma_f32_32x32x16_bf16 v[240:255], v[220:223], v[116:119], v[240:255]
    v_mfma_f32_32x32x16_bf16 v[224:239], v[48:51], v[120:123], v[224:239]
    v_mfma_f32_32x32x16_bf16 v[240:255], v[52:55], v[120:123], v[240:255]
    v_mfma_f32_32x32x16_bf16 v[224:239], v[56:59], v[124:127], v[224:239]
    v_mfma_f32_32x32x16_bf16 v[240:255], v[60:63], v[124:127], v[240:255]
    s_mov_b32 s61, 300000
lw_122:
    ds_read_b32 v12, v5 offset:144
    s_waitcnt lgkmcnt(0)
    v_readfirstlane_b32 s60, v12
    s_sub_u32 s61, s61, 1
    s_cbranch_scc1 lwd_123
    s_cmp_ge_u32 s60, 4
    s_cbranch_scc1 lwd_123
    s_branch lw_122
lwd_123:
    ds_read_b128 v[128:131], v40 offset:0
    ds_read_b128 v[132:135], v41 offset:0
    ds_read_b128 v[136:139], v42 offset:0
    ds_read_b128 v[140:143], v43 offset:0
    ds_read_b64_tr_b16 v[176:177], v17 offset:16384
    ds_read_b64_tr_b16 v[178:179], v17 offset:16640
    ds_read_b64_tr_b16 v[180:181], v17 offset:45056
    ds_read_b64_tr_b16 v[182:183], v17 offset:45312
    ds_read_b64_tr_b16 v[184:185], v17 offset:17408
    ds_read_b64_tr_b16 v[186:187], v17 offset:17664
    ds_read_b64_tr_b16 v[188:189], v17 offset:46080
    ds_read_b64_tr_b16 v[190:191], v17 offset:46336
    ds_read_b64_tr_b16 v[192:193], v17 offset:18432
    ds_read_b64_tr_b16 v[194:195], v17 offset:18688
    ds_read_b64_tr_b16 v[196:197], v17 offset:47104
    ds_read_b64_tr_b16 v[198:199], v17 offset:47360
    ds_read_b64_tr_b16 v[200:201], v17 offset:19456
    ds_read_b64_tr_b16 v[202:203], v17 offset:19712
    ds_read_b64_tr_b16 v[204:205], v17 offset:48128
    ds_read_b64_tr_b16 v[206:207], v17 offset:48384
    ds_read_b32 v13, v5 offset:148
    s_branch fok_39
fslow_40:
    v_mfma_f32_32x32x16_bf16 v[240:255], v[180:183], v[128:131], v[240:255]
    v_mfma_f32_32x32x16_bf16 v[224:239], v[184:187], v[132:135], v[224:239]
    v_mfma_f32_32x32x16_bf16 v[240:255], v[188:191], v[132:135], v[240:255]
    v_mfma_f32_32x32x16_bf16 v[224:239], v[192:195], v[136:139], v[224:239]
    v_mfma_f32_32x32x16_bf16 v[240:255], v[196:199], v[136:139], v[240:255]
    v_mfma_f32_32x32x16_bf16 v[224:239], v[200:203], v[140:143], v[224:239]
    v_mfma_f32_32x32x16_bf16 v[240:255], v[204:207], v[140:143], v[240:255]
    s_mov_b32 s61, 300000
lw_124:
    ds_read_b32 v12, v5 offset:148
    s_waitcnt lgkmcnt(0)
    v_readfirstlane_b32 s60, v12
    s_sub_u32 s61, s61, 1
    s_cbranch_scc1 lwd_125
    s_cmp_ge_u32 s60, 4
    s_cbranch_scc1 lwd_125
    s_branch lw_124
lwd_125:
    ds_read_b128 v[144:147], v40 offset:4096
    ds_read_b128 v[148:151], v41 offset:4096
    ds_read_b128 v[152:155], v42 offset:4096
    ds_read_b128 v[156:159], v43 offset:4096
    ds_read_b64_tr_b16 v[208:209], v17 offset:20480
    ds_read_b64_tr_b16 v[210:211], v17 offset:20736
    ds_read_b64_tr_b16 v[212:213], v17 offset:49152
    ds_read_b64_tr_b16 v[214:215], v17 offset:49408
    ds_read_b64_tr_b16 v[216:217], v17 offset:21504
    ds_read_b64_tr_b16 v[218:219], v17 offset:21760
    ds_read_b64_tr_b16 v[220:221], v17 offset:50176
    ds_read_b64_tr_b16 v[222:223], v17 offset:50432
    ds_read_b64_tr_b16 v[48:49], v17 offset:22528
    ds_read_b64_tr_b16 v[50:51], v17 offset:22784
    ds_read_b64_tr_b16 v[52:53], v17 offset:51200
    ds_read_b64_tr_b16 v[54:55], v17 offset:51456
    ds_read_b64_tr_b16 v[56:57], v17 offset:23552
    ds_read_b64_tr_b16 v[58:59], v17 offset:23808
    ds_read_b64_tr_b16 v[60:61], v17 offset:52224
    ds_read_b64_tr_b16 v[62:63], v17 offset:52480
    ds_read_b32 v13, v5 offset:152
    s_branch fok_41
fslow_42:
    v_mfma_f32_32x32x16_bf16 v[240:255], v[212:215], v[144:147], v[240:255]
    v_mfma_f32_32x32x16_bf16 v[224:239], v[216:219], v[148:151], v[224:239]
    v_mfma_f32_32x32x16_bf16 v[240:255], v[220:223], v[148:151], v[240:255]
    v_mfma_f32_32x32x16_bf16 v[224:239], v[48:51], v[152:155], v[224:239]
    v_mfma_f32_32x32x16_bf16 v[240:255], v[52:55], v[152:155], v[240:255]
    v_mfma_f32_32x32x16_bf16 v[224:239], v[56:59], v[156:159], v[224:239]
    v_mfma_f32_32x32x16_bf16 v[240:255], v[60:63], v[156:159], v[240:255]
    s_mov_b32 s61, 300000
lw_126:
    ds_read_b32 v12, v5 offset:152
    s_waitcnt lgkmcnt(0)
    v_readfirstlane_b32 s60, v12
    s_sub_u32 s61, s61, 1
    s_cbranch_scc1 lwd_127
    s_cmp_ge_u32 s60, 4
    s_cbranch_scc1 lwd_127
    s_branch lw_126
lwd_127:
    ds_read_b128 v[160:163], v40 offset:8192
    ds_read_b128 v[164:167], v41 offset:8192
    ds_read_b128 v[168:171], v42 offset:8192
    ds_read_b128 v[172:175], v43 offset:8192
    s_mov_b64 exec, 1
    ds_add_u32 v5, v6 offset:172
    s_mov_b64 exec, -1
    ds_read_b64_tr_b16 v[176:177], v17 offset:24576
    ds_read_b64_tr_b16 v[178:179], v17 offset:24832
    ds_read_b64_tr_b16 v[180:181], v17 offset:53248
    ds_read_b64_tr_b16 v[182:183], v17 offset:53504
    ds_read_b64_tr_b16 v[184:185], v17 offset:25600
    ds_read_b64_tr_b16 v[186:187], v17 offset:25856
    ds_read_b64_tr_b16 v[188:189], v17 offset:54272
    ds_read_b64_tr_b16 v[190:191], v17 offset:54528
    ds_read_b64_tr_b16 v[192:193], v17 offset:26624
    ds_read_b64_tr_b16 v[194:195], v17 offset:26880
    ds_read_b64_tr_b16 v[196:197], v17 offset:55296
    ds_read_b64_tr_b16 v[198:199], v17 offset:55552
    ds_read_b64_tr_b16 v[200:201], v17 offset:27648
    ds_read_b64_tr_b16 v[202:203], v17 offset:27904
    ds_read_b64_tr_b16 v[204:205], v17 offset:56320
    ds_read_b64_tr_b16 v[206:207], v17 offset:56576
    s_branch fok_43
fslow_46:
    v_mfma_f32_32x32x16_bf16 v[240:255], v[180:183], v[68:71], v[240:255]
    v_mfma_f32_32x32x16_bf16 v[240:255], v[184:187], v[72:75], v[240:255]
    v_mfma_f32_32x32x16_bf16 v[240:255], v[188:191], v[76:79], v[240:255]
    s_mov_b32 s61, 300000
lw_128:
    ds_read_b32 v12, v5 offset:132
    s_waitcnt lgkmcnt(0)
    v_readfirstlane_b32 s60, v12
    s_sub_u32 s61, s61, 1
    s_cbranch_scc1 lwd_129
    s_cmp_ge_u32 s60, 4
    s_cbranch_scc1 lwd_129
    s_branch lw_128
lwd_129:
    ds_read_b128 v[80:83], v40 offset:4096
    ds_read_b128 v[84:87], v41 offset:4096
    ds_read_b128 v[88:91], v42 offset:4096
    ds_read_b128 v[92:95], v43 offset:4096
    s_mov_b64 exec, 1
    ds_add_u32 v5, v6 offset:164
    s_mov_b64 exec, -1
    ds_read_b64_tr_b16 v[208:209], v44 offset:4096
    ds_read_b64_tr_b16 v[210:211], v44 offset:4320
    ds_read_b64_tr_b16 v[212:213], v44 offset:5120
    ds_read_b64_tr_b16 v[214:215], v44 offset:5344
    ds_read_b64_tr_b16 v[216:217], v44 offset:6144
    ds_read_b64_tr_b16 v[218:219], v44 offset:6368
    ds_read_b64_tr_b16 v[220:221], v44 offset:7168
    ds_read_b64_tr_b16 v[222:223], v44 offset:7392
    ds_read_b32 v13, v5 offset:136
    s_branch fok_47
fslow_48:
    v_mfma_f32_32x32x16_bf16 v[240:255], v[212:215], v[84:87], v[240:255]
    v_mfma_f32_32x32x16_bf16 v[240:255], v[216:219], v[88:91], v[240:255]
    v_mfma_f32_32x32x16_bf16 v[240:255], v[220:223], v[92:95], v[240:255]
    s_mov_b32 s61, 300000
lw_130:
    ds_read_b32 v12, v5 offset:136
    s_waitcnt lgkmcnt(0)
    v_readfirstlane_b32 s60, v12
    s_sub_u32 s61, s61, 1
    s_cbranch_scc1 lwd_131
    s_cmp_ge_u32 s60, 4
    s_cbranch_scc1 lwd_131
    s_branch lw_130
lwd_131:
    ds_read_b128 v[96:99], v40 offset:8192
    ds_read_b128 v[100:103], v41 offset:8192
    ds_read_b128 v[104:107], v42 offset:8192
    ds_read_b128 v[108:111], v43 offset:8192
    s_mov_b64 exec, 1
    ds_add_u32 v5, v6 offset:168
    s_mov_b64 exec, -1
    ds_read_b64_tr_b16 v[176:177], v44 offset:8192
    ds_read_b64_tr_b16 v[178:179], v44 offset:8416
    ds_read_b64_tr_b16 v[180:181], v44 offset:9216
    ds_read_b64_tr_b16 v[182:183], v44 offset:9440
    ds_read_b64_tr_b16 v[184:185], v44 offset:10240
    ds_read_b64_tr_b16 v[186:187], v44 offset:10464
    ds_read_b64_tr_b16 v[188:189], v44 offset:11264
    ds_read_b64_tr_b16 v[190:191], v44 offset:11488
    ds_read_b32 v13, v5 offset:140
    s_branch fok_49
fslow_50:
    v_mfma_f32_32x32x16_bf16 v[240:255], v[180:183], v[100:103], v[240:255]
    v_mfma_f32_32x32x16_bf16 v[240:255], v[184:187], v[104:107], v[240:255]
    v_mfma_f32_32x32x16_bf16 v[240:255], v[188:191], v[108:111], v[240:255]
    s_mov_b32 s61, 300000
lw_132:
    ds_read_b32 v12, v5 offset:140
    s_waitcnt lgkmcnt(0)
    v_readfirstlane_b32 s60, v12
    s_sub_u32 s61, s61, 1
    s_cbranch_scc1 lwd_133
    s_cmp_ge_u32 s60, 4
    s_cbranch_scc1 lwd_133
    s_branch lw_132
lwd_133:
    ds_read_b128 v[112:115], v40 offset:12288
    ds_read_b128 v[116:119], v41 offset:12288
    ds_read_b128 v[120:123], v42 offset:12288
    ds_read_b128 v[124:127], v43 offset:12288
    ds_read_b64_tr_b16 v[208:209], v44 offset:12288
    ds_read_b64_tr_b16 v[210:211], v44 offset:12512
    ds_read_b64_tr_b16 v[212:213], v44 offset:13312
    ds_read_b64_tr_b16 v[214:215], v44 offset:13536
    ds_read_b64_tr_b16 v[216:217], v44 offset:14336
    ds_read_b64_tr_b16 v[218:219], v44 offset:14560
    ds_read_b64_tr_b16 v[220:221], v44 offset:15360
    ds_read_b64_tr_b16 v[222:223], v44 offset:15584
    ds_read_b32 v13, v5 offset:144
    s_branch fok_51
fslow_52:
    v_mfma_f32_32x32x16_bf16 v[240:255], v[212:215], v[116:119], v[240:255]
    v_mfma_f32_32x32x16_bf16 v[240:255], v[216:219], v[120:123], v[240:255]
    v_mfma_f32_32x32x16_bf16 v[240:255], v[220:223], v[124:127], v[240:255]
    s_mov_b32 s61, 300000
lw_134:
    ds_read_b32 v12, v5 offset:144
    s_waitcnt lgkmcnt(0)
    v_readfirstlane_b32 s60, v12
    s_sub_u32 s61, s61, 1
    s_cbranch_scc1 lwd_135
    s_cmp_ge_u32 s60, 4
    s_cbranch_scc1 lwd_135
    s_branch lw_134
lwd_135:
    ds_read_b128 v[128:131], v40 offset:0
    ds_read_b128 v[132:135], v41 offset:0
    ds_read_b128 v[136:139], v42 offset:0
    ds_read_b128 v[140:143], v43 offset:0
    ds_read_b64_tr_b16 v[176:177], v44 offset:16384
    ds_read_b64_tr_b16 v[178:179], v44 offset:16608
    ds_read_b64_tr_b16 v[180:181], v44 offset:17408
    ds_read_b64_tr_b16 v[182:183], v44 offset:17632
    ds_read_b64_tr_b16 v[184:185], v44 offset:18432
    ds_read_b64_tr_b16 v[186:187], v44 offset:18656
    ds_read_b64_tr_b16 v[188:189], v44 offset:19456
    ds_read_b64_tr_b16 v[190:191], v44 offset:19680
    ds_read_b32 v13, v5 offset:148
    s_branch fok_53
fslow_54:
    v_mfma_f32_32x32x16_bf16 v[240:255], v[180:183], v[132:135], v[240:255]
    v_mfma_f32_32x32x16_bf16 v[240:255], v[184:187], v[136:139], v[240:255]
    v_mfma_f32_32x32x16_bf16 v[240:255], v[188:191], v[140:143], v[240:255]
    s_mov_b32 s61, 300000
lw_136:
    ds_read_b32 v12, v5 offset:148
    s_waitcnt lgkmcnt(0)
    v_readfirstlane_b32 s60, v12
    s_sub_u32 s61, s61, 1
    s_cbranch_scc1 lwd_137
    s_cmp_ge_u32 s60, 4
    s_cbranch_scc1 lwd_137
    s_branch lw_136
lwd_137:
    ds_read_b128 v[144:147], v40 offset:4096
    ds_read_b128 v[148:151], v41 offset:4096
    ds_read_b128 v[152:155], v42 offset:4096
    ds_read_b128 v[156:159], v43 offset:4096
    ds_read_b64_tr_b16 v[208:209], v44 offset:20480
    ds_read_b64_tr_b16 v[210:211], v44 offset:20704
    ds_read_b64_tr_b16 v[212:213], v44 offset:21504
    ds_read_b64_tr_b16 v[214:215], v44 offset:21728
    ds_read_b64_tr_b16 v[216:217], v44 offset:22528
    ds_read_b64_tr_b16 v[218:219], v44 offset:22752
    ds_read_b64_tr_b16 v[220:221], v44 offset:23552
    ds_read_b64_tr_b16 v[222:223], v44 offset:23776
    ds_read_b32 v13, v5 offset:152
    s_branch fok_55
fslow_56:
    v_mfma_f32_32x32x16_bf16 v[240:255], v[212:215], v[148:151], v[240:255]
    v_mfma_f32_32x32x16_bf16 v[240:255], v[216:219], v[152:155], v[240:255]
    v_mfma_f32_32x32x16_bf16 v[240:255], v[220:223], v[156:159], v[240:255]
    s_mov_b32 s61, 300000
lw_138:
    ds_read_b32 v12, v5 offset:152
    s_waitcnt lgkmcnt(0)
    v_readfirstlane_b32 s60, v12
    s_sub_u32 s61, s61, 1
    s_cbranch_scc1 lwd_139
    s_cmp_ge_u32 s60, 4
    s_cbranch_scc1 lwd_139
    s_branch lw_138
lwd_139:
    ds_read_b128 v[160:163], v40 offset:8192
    ds_read_b128 v[164:167], v41 offset:8192
    ds_read_b128 v[168:171], v42 offset:8192
    ds_read_b128 v[172:175], v43 offset:8192
    s_mov_b64 exec, 1
    ds_add_u32 v5, v6 offset:172
    s_mov_b64 exec, -1
    ds_read_b64_tr_b16 v[176:177], v44 offset:24576
    ds_read_b64_tr_b16 v[178:179], v44 offset:24800
    ds_read_b64_tr_b16 v[180:181], v44 offset:25600
    ds_read_b64_tr_b16 v[182:183], v44 offset:25824
    ds_read_b64_tr_b16 v[184:185], v44 offset:26624
    ds_read_b64_tr_b16 v[186:187], v44 offset:26848
    ds_read_b64_tr_b16 v[188:189], v44 offset:27648
    ds_read_b64_tr_b16 v[190:191], v44 offset:27872
    s_branch fok_57
fslow_60:
    v_mfma_f32_32x32x16_bf16 v[240:255], v[68:71], v[180:183], v[240:255]
    v_mfma_f32_32x32x16_bf16 v[240:255], v[72:75], v[184:187], v[240:255]
    v_mfma_f32_32x32x16_bf16 v[240:255], v[76:79], v[188:191], v[240:255]
    s_mov_b32 s61, 300000
lw_140:
    ds_read_b32 v12, v5 offset:132
    s_waitcnt lgkmcnt(0)
    v_readfirstlane_b32 s60, v12
    s_sub_u32 s61, s61, 1
    s_cbranch_scc1 lwd_141
    s_cmp_ge_u32 s60, 4
    s_cbranch_scc1 lwd_141
    s_branch lw_140
lwd_141:
    ds_read_b128 v[80:83], v40 offset:4096
    ds_read_b128 v[84:87], v41 offset:4096
    ds_read_b128 v[88:91], v42 offset:4096
    ds_read_b128 v[92:95], v43 offset:4096
    s_mov_b64 exec, 1
    ds_add_u32 v5, v6 offset:164
    s_mov_b64 exec, -1
    ds_read_b64_tr_b16 v[208:209], v44 offset:4096
    ds_read_b64_tr_b16 v[210:211], v44 offset:4320
    ds_read_b64_tr_b16 v[212:213], v44 offset:5120
    ds_read_b64_tr_b16 v[214:215], v44 offset:5344
    ds_read_b64_tr_b16 v[216:217], v44 offset:6144
    ds_read_b64_tr_b16 v[218:219], v44 offset:6368
    ds_read_b64_tr_b16 v[220:221], v44 offset:7168
    ds_read_b64_tr_b16 v[222:223], v44 offset:7392
    ds_read_b32 v13, v5 offset:136
    s_branch fok_61
fslow_62:
    v_mfma_f32_32x32x16_bf16 v[240:255], v[84:87], v[212:215], v[240:255]
    v_mfma_f32_32x32x16_bf16 v[240:255], v[88:91], v[216:219], v[240:255]
    v_mfma_f32_32x32x16_bf16 v[240:255], v[92:95], v[220:223], v[240:255]
    s_mov_b32 s61, 300000
lw_142:
    ds_read_b32 v12, v5 offset:136
    s_waitcnt lgkmcnt(0)
    v_readfirstlane_b32 s60, v12
    s_sub_u32 s61, s61, 1
    s_cbranch_scc1 lwd_143
    s_cmp_ge_u32 s60, 4
    s_cbranch_scc1 lwd_143
    s_branch lw_142
lwd_143:
    ds_read_b128 v[96:99], v40 offset:8192
    ds_read_b128 v[100:103], v41 offset:8192
    ds_read_b128 v[104:107], v42 offset:8192
    ds_read_b128 v[108:111], v43 offset:8192
    s_mov_b64 exec, 1
    ds_add_u32 v5, v6 offset:168
    s_mov_b64 exec, -1
    ds_read_b64_tr_b16 v[176:177], v44 offset:8192
    ds_read_b64_tr_b16 v[178:179], v44 offset:8416
    ds_read_b64_tr_b16 v[180:181], v44 offset:9216
    ds_read_b64_tr_b16 v[182:183], v44 offset:9440
    ds_read_b64_tr_b16 v[184:185], v44 offset:10240
    ds_read_b64_tr_b16 v[186:187], v44 offset:10464
    ds_read_b64_tr_b16 v[188:189], v44 offset:11264
    ds_read_b64_tr_b16 v[190:191], v44 offset:11488
    ds_read_b32 v13, v5 offset:140
    s_branch fok_63
fslow_64:
    v_mfma_f32_32x32x16_bf16 v[240:255], v[100:103], v[180:183], v[240:255]
    v_mfma_f32_32x32x16_bf16 v[240:255], v[104:107], v[184:187], v[240:255]
    v_mfma_f32_32x32x16_bf16 v[240:255], v[108:111], v[188:191], v[240:255]
    s_mov_b32 s61, 300000
lw_144:
    ds_read_b32 v12, v5 offset:140
    s_waitcnt lgkmcnt(0)
    v_readfirstlane_b32 s60, v12
    s_sub_u32 s61, s61, 1
    s_cbranch_scc1 lwd_145
    s_cmp_ge_u32 s60, 4
    s_cbranch_scc1 lwd_145
    s_branch lw_144
lwd_145:
    ds_read_b128 v[112:115], v40 offset:12288
    ds_read_b128 v[116:119], v41 offset:12288
    ds_read_b128 v[120:123], v42 offset:12288
    ds_read_b128 v[124:127], v43 offset:12288
    ds_read_b64_tr_b16 v[208:209], v44 offset:12288
    ds_read_b64_tr_b16 v[210:211], v44 offset:12512
    ds_read_b64_tr_b16 v[212:213], v44 offset:13312
    ds_read_b64_tr_b16 v[214:215], v44 offset:13536
    ds_read_b64_tr_b16 v[216:217], v44 offset:14336
    ds_read_b64_tr_b16 v[218:219], v44 offset:14560
    ds_read_b64_tr_b16 v[220:221], v44 offset:15360
    ds_read_b64_tr_b16 v[222:223], v44 offset:15584
    ds_read_b32 v13, v5 offset:144
    s_branch fok_65
fslow_66:
    v_mfma_f32_32x32x16_bf16 v[240:255], v[116:119], v[212:215], v[240:255]
    v_mfma_f32_32x32x16_bf16 v[240:255], v[120:123], v[216:219], v[240:255]
    v_mfma_f32_32x32x16_bf16 v[240:255], v[124:127], v[220:223], v[240:255]
    s_mov_b32 s61, 300000
lw_146:
    ds_read_b32 v12, v5 offset:144
    s_waitcnt lgkmcnt(0)
    v_readfirstlane_b32 s60, v12
    s_sub_u32 s61, s61, 1
    s_cbranch_scc1 lwd_147
    s_cmp_ge_u32 s60, 4
    s_cbranch_scc1 lwd_147
    s_branch lw_146
lwd_147:
    ds_read_b128 v[128:131], v40 offset:0
    ds_read_b128 v[132:135], v41 offset:0
    ds_read_b128 v[136:139], v42 offset:0
    ds_read_b128 v[140:143], v43 offset:0
    ds_read_b64_tr_b16 v[176:177], v44 offset:16384
    ds_read_b64_tr_b16 v[178:179], v44 offset:16608
    ds_read_b64_tr_b16 v[180:181], v44 offset:17408
    ds_read_b64_tr_b16 v[182:183], v44 offset:17632
    ds_read_b64_tr_b16 v[184:185], v44 offset:18432
    ds_read_b64_tr_b16 v[186:187], v44 offset:18656
    ds_read_b64_tr_b16 v[188:189], v44 offset:19456
    ds_read_b64_tr_b16 v[190:191], v44 offset:19680
    ds_read_b32 v13, v5 offset:148
    s_branch fok_67
fslow_68:
    v_mfma_f32_32x32x16_bf16 v[240:255], v[132:135], v[180:183], v[240:255]
    v_mfma_f32_32x32x16_bf16 v[240:255], v[136:139], v[184:187], v[240:255]
    v_mfma_f32_32x32x16_bf16 v[240:255], v[140:143], v[188:191], v[240:255]
    s_mov_b32 s61, 300000
lw_148:
    ds_read_b32 v12, v5 offset:148
    s_waitcnt lgkmcnt(0)
    v_readfirstlane_b32 s60, v12
    s_sub_u32 s61, s61, 1
    s_cbranch_scc1 lwd_149
    s_cmp_ge_u32 s60, 4
    s_cbranch_scc1 lwd_149
    s_branch lw_148
lwd_149:
    ds_read_b128 v[144:147], v40 offset:4096
    ds_read_b128 v[148:151], v41 offset:4096
    ds_read_b128 v[152:155], v42 offset:4096
    ds_read_b128 v[156:159], v43 offset:4096
    ds_read_b64_tr_b16 v[208:209], v44 offset:20480
    ds_read_b64_tr_b16 v[210:211], v44 offset:20704
    ds_read_b64_tr_b16 v[212:213], v44 offset:21504
    ds_read_b64_tr_b16 v[214:215], v44 offset:21728
    ds_read_b64_tr_b16 v[216:217], v44 offset:22528
    ds_read_b64_tr_b16 v[218:219], v44 offset:22752
    ds_read_b64_tr_b16 v[220:221], v44 offset:23552
    ds_read_b64_tr_b16 v[222:223], v44 offset:23776
    ds_read_b32 v13, v5 offset:152
    s_branch fok_69
fslow_70:
    v_mfma_f32_32x32x16_bf16 v[240:255], v[148:151], v[212:215], v[240:255]
    v_mfma_f32_32x32x16_bf16 v[240:255], v[152:155], v[216:219], v[240:255]
    v_mfma_f32_32x32x16_bf16 v[240:255], v[156:159], v[220:223], v[240:255]
    s_mov_b32 s61, 300000
lw_150:
    ds_read_b32 v12, v5 offset:152
    s_waitcnt lgkmcnt(0)
    v_readfirstlane_b32 s60, v12
    s_sub_u32 s61, s61, 1
    s_cbranch_scc1 lwd_151
    s_cmp_ge_u32 s60, 4
    s_cbranch_scc1 lwd_151
    s_branch lw_150
lwd_151:
    ds_read_b128 v[160:163], v40 offset:8192
    ds_read_b128 v[164:167], v41 offset:8192
    ds_read_b128 v[168:171], v42 offset:8192
    ds_read_b128 v[172:175], v43 offset:8192
    s_mov_b64 exec, 1
    ds_add_u32 v5, v6 offset:172
    s_mov_b64 exec, -1
    ds_read_b64_tr_b16 v[176:177], v44 offset:24576
    ds_read_b64_tr_b16 v[178:179], v44 offset:24800
    ds_read_b64_tr_b16 v[180:181], v44 offset:25600
    ds_read_b64_tr_b16 v[182:183], v44 offset:25824
    ds_read_b64_tr_b16 v[184:185], v44 offset:26624
    ds_read_b64_tr_b16 v[186:187], v44 offset:26848
    ds_read_b64_tr_b16 v[188:189], v44 offset:27648
    ds_read_b64_tr_b16 v[190:191], v44 offset:27872
    s_branch fok_71
cslow_110:
    v_mfma_f32_32x32x16_bf16 v[112:127], v[148:151], v[68:71], v[112:127]
    v_mfma_f32_32x32x16_bf16 v[112:127], v[152:155], v[72:75], v[112:127]
    v_mfma_f32_32x32x16_bf16 v[112:127], v[156:159], v[76:79], v[112:127]
    s_mov_b32 s61, 300000
lw_152:
    ds_read_b32 v12, v5 offset:116
    s_waitcnt lgkmcnt(0)
    v_readfirstlane_b32 s60, v12
    s_sub_u32 s61, s61, 1
    s_cbranch_scc1 lwd_153
    s_cmp_ge_u32 s60, 4
    s_cbranch_scc1 lwd_153
    s_branch lw_152
lwd_153:
    ds_read_b128 v[80:83], v13 offset:8192
    ds_read_b128 v[84:87], v13 offset:9216
    ds_read_b128 v[88:91], v13 offset:10240
    ds_read_b128 v[92:95], v13 offset:11264
    ds_read_b128 v[96:99], v13 offset:12288
    ds_read_b128 v[100:103], v13 offset:13312
    ds_read_b128 v[104:107], v13 offset:14336
    ds_read_b128 v[108:111], v13 offset:15360
    ds_read_b32 v14, v5 offset:120
    s_branch cok_111
cslow_112:
    v_mfma_f32_32x32x16_bf16 v[112:127], v[180:183], v[100:103], v[112:127]
    v_mfma_f32_32x32x16_bf16 v[112:127], v[184:187], v[104:107], v[112:127]
    v_mfma_f32_32x32x16_bf16 v[112:127], v[188:191], v[108:111], v[112:127]
    s_mov_b32 s61, 300000
lw_154:
    ds_read_b32 v12, v5 offset:120
    s_waitcnt lgkmcnt(0)
    v_readfirstlane_b32 s60, v12
    s_sub_u32 s61, s61, 1
    s_cbranch_scc1 lwd_155
    s_cmp_ge_u32 s60, 4
    s_cbranch_scc1 lwd_155
    s_branch lw_154
lwd_155:
    ds_read_b128 v[48:51], v13 offset:16384
    ds_read_b128 v[52:55], v13 offset:17408
    ds_read_b128 v[56:59], v13 offset:18432
    ds_read_b128 v[60:63], v13 offset:19456
    ds_read_b128 v[64:67], v13 offset:20480
    ds_read_b128 v[68:71], v13 offset:21504
    ds_read_b128 v[72:75], v13 offset:22528
    ds_read_b128 v[76:79], v13 offset:23552
    ds_read_b32 v14, v5 offset:124
    s_branch cok_113
cslow_114:
    v_mfma_f32_32x32x16_bf16 v[112:127], v[212:215], v[68:71], v[112:127]
    v_mfma_f32_32x32x16_bf16 v[112:127], v[216:219], v[72:75], v[112:127]
    v_mfma_f32_32x32x16_bf16 v[112:127], v[220:223], v[76:79], v[112:127]
    s_mov_b32 s61, 300000
lw_156:
    ds_read_b32 v12, v5 offset:124
    s_waitcnt lgkmcnt(0)
    v_readfirstlane_b32 s60, v12
    s_sub_u32 s61, s61, 1
    s_cbranch_scc1 lwd_157
    s_cmp_ge_u32 s60, 4
    s_cbranch_scc1 lwd_157
    s_branch lw_156
lwd_157:
    ds_read_b128 v[80:83], v13 offset:24576
    ds_read_b128 v[84:87], v13 offset:25600
    ds_read_b128 v[88:91], v13 offset:26624
    ds_read_b128 v[92:95], v13 offset:27648
    ds_read_b128 v[96:99], v13 offset:28672
    ds_read_b128 v[100:103], v13 offset:29696
    ds_read_b128 v[104:107], v13 offset:30720
    ds_read_b128 v[108:111], v13 offset:31744
    s_branch cok_115
L_fin:
L_end:
    s_endpgm
.set CODE_LAST, L_end - gated_mix__linear_kernel_hedgehog__grouped_kv_mqa__prompt_kernel - 64
.section .rodata,"a"
.p2align 6
.amdhsa_kernel gated_mix__linear_kernel_hedgehog__grouped_kv_mqa__prompt_kernel
  .amdhsa_next_free_vgpr 256
  .amdhsa_next_free_sgpr 102
  .amdhsa_accum_offset 256
  .amdhsa_group_segment_fixed_size 0
  .amdhsa_kernarg_size 104
  .amdhsa_user_sgpr_count 2
  .amdhsa_user_sgpr_kernarg_segment_ptr 1
  .amdhsa_system_sgpr_workgroup_id_x 1
.end_amdhsa_kernel
```
